```python
import torch

def _softmax(x, axis=-1):
    return torch.softmax(x, dim=axis)
def _gelu(x):
    return torch.nn.functional.gelu(x, approximate="tanh")
def _silu(x):
    return torch.nn.functional.silu(x)
def _sigmoid(x):
    return torch.sigmoid(x)
def _layernorm(x, axis=-1, eps=1e-5):
    m = x.mean(dim=axis, keepdim=True)
    v = x.var(dim=axis, keepdim=True, unbiased=False)
    return (x - m) / torch.sqrt(v + eps)
def _scatter_add(tgt, idx, src, axis=0):
    return tgt.clone().index_add_(axis, idx, src)
def _segment_sum(src, seg, n):
    out = torch.zeros((n,) + src.shape[1:], dtype=src.dtype)
    return out.index_add_(0, seg, src)
def _pad(x, pw):
    flat = tuple(v for pair in reversed(pw) for v in pair)
    return torch.nn.functional.pad(x, flat)

kernel_name = 'parallel_sum__sliding_block_cached__glu_gated_glu__decode'

def setup_inputs():

    _w = (lambda a: (lambda t: t.to(torch.bfloat16) if t.is_floating_point() else t)(torch.as_tensor(a)))
    def _A_setup():
        B, Sq, D = 1, 1, 640
        Hq, Hkv, Sk, Dh = 32, 32, 32768, 128
        assert Hq % Hkv == 0, (Hq, Hkv)
        return {
            "x": _w((lambda *s: torch.randn(*s, dtype=torch.bfloat16) * 0.05)(B, Sq, D)),
            "k_cache": _w((lambda *s: torch.randn(*s, dtype=torch.bfloat16) * 3.2)(B, Hkv, Sk, Dh)),
            "v_cache": _w((lambda *s: torch.randn(*s, dtype=torch.bfloat16) * 1.6)(B, Hkv, Sk, Dh)),
            "wq": _w((lambda *s: torch.randn(*s, dtype=torch.bfloat16) * 3.2)(D, Hq * Dh) * (D ** -0.5)),
            "wo": _w((lambda *s: torch.randn(*s, dtype=torch.bfloat16) * 1.6)(Hq * Dh, D) * ((Hq * Dh) ** -0.5)),
        }
    _A_in = _A_setup()

    def _B_setup():
        B, S, D, F = 1, 1, 640, 1728
        return {
            "x": _w((lambda *s: torch.randn(*s, dtype=torch.bfloat16) * 0.05)(B, S, D)),
            "w_gate": _w((lambda *s: torch.randn(*s, dtype=torch.bfloat16) * 0.2)(D, F)),
            "w_up": _w((lambda *s: torch.randn(*s, dtype=torch.bfloat16) * 0.05)(D, F)),
            "w_down": _w((lambda *s: torch.randn(*s, dtype=torch.bfloat16) * 0.05)(F, D)),
        }
    _B_in = _B_setup()

    return {
        "A_x": _A_in["x"],
        "A_k_cache": _A_in["k_cache"],
        "A_v_cache": _A_in["v_cache"],
        "A_wq": _A_in["wq"],
        "A_wo": _A_in["wo"],
        "B_x": _B_in["x"],
        "B_w_gate": _B_in["w_gate"],
        "B_w_up": _B_in["w_up"],
        "B_w_down": _B_in["w_down"],
    }

def reference(A_x, A_k_cache, A_v_cache, A_wq, A_wo, B_x, B_w_gate, B_w_up, B_w_down):
    def _A_ref(x, k_cache, v_cache, wq, wo):
        B, Sq, D = x.shape
        Hq, Dh = 32, 128
        Hkv, Sk = k_cache.shape[1], k_cache.shape[2]
        W = min(4096, max(256, Sk // 4))
        rep = Hq // Hkv
        q = (lambda x, *d: x.permute(*d))((x @ wq).reshape(B, Sq, Hq, Dh), 0, 2, 1, 3)
        k = (lambda x, n, axis: torch.repeat_interleave(x, n, dim=axis))(k_cache[:, :, Sk - W:, :], rep, axis=1)
        v = (lambda x, n, axis: torch.repeat_interleave(x, n, dim=axis))(v_cache[:, :, Sk - W:, :], rep, axis=1)
        scores = torch.einsum("bhqd,bhkd->bhqk", q, k) * (Dh ** -0.5)
        p = _softmax(scores, axis=-1)
        o = torch.einsum("bhqk,bhkd->bhqd", p, v)
        return (lambda x, *d: x.permute(*d))(o, 0, 2, 1, 3).reshape(B, Sq, Hq * Dh) @ wo

    def _B_ref(x, w_gate, w_up, w_down):
        g = torch.einsum("bsd,df->bsf", x, w_gate)
        u = torch.einsum("bsd,df->bsf", x, w_up)
        h = _sigmoid(g) * u
        return torch.einsum("bsf,fd->bsd", h, w_down)

    x = A_x
    xn = _layernorm(x, axis=-1)
    return x + _A_ref(xn, A_k_cache, A_v_cache, A_wq, A_wo) + _B_ref(xn, B_w_gate, B_w_up, B_w_down)
```

```asm
; @launch grid=(256,1,1) block=(512,1,1) lds=22656
.amdgcn_target "amdgcn-amd-amdhsa--gfx950"
.text
.globl parallel_sum__sliding_block_cached__glu_gated_glu__decode_kernel
.p2align 8
.type parallel_sum__sliding_block_cached__glu_gated_glu__decode_kernel,@function
parallel_sum__sliding_block_cached__glu_gated_glu__decode_kernel:
  s_load_dwordx16 s[4:19], s[0:1], 0
  s_load_dwordx8 s[20:27], s[0:1], 64
  s_cmp_ge_u32 s2, 256
  s_cbranch_scc1 L_end
  s_and_b32 s28, s2, 31
  s_lshr_b32 s29, s2, 5
  v_lshlrev_b32 v1, 4, v0
  v_lshrrev_b32 v2, 6, v0
  v_and_b32 v0, 63, v0
  v_readfirstlane_b32 s3, v2
  v_lshrrev_b32 v15, 4, v0
  v_and_b32 v3, 15, v0
  v_mul_u32_u24 v5, 10, v2
  v_add_u32 v5, v5, v15
  v_lshlrev_b32 v10, 13, v5
  v_lshl_add_u32 v10, v3, 4, v10
  v_mul_u32_u24 v9, 20, v0
  v_lshrrev_b32 v6, 3, v0
  s_movk_i32 s39, 3456
  v_mul_lo_u32 v11, v6, s39
  v_and_b32 v7, 7, v0
  v_lshl_add_u32 v11, v7, 4, v11
  v_mov_b32 v97, 0
  v_cmp_gt_u32 s[34:35], 10, v3
  v_cmp_gt_u32 s[36:37], 4, v6
  v_cmp_gt_u32 s[54:55], 32, v0
  v_and_b32 v7, 2, v0
  v_cmp_ne_u32 s[30:31], 0, v7
  v_and_b32 v7, 1, v0
  v_cmp_ne_u32 s[52:53], 0, v7
  s_lshl_b32 s38, s28, 23
  s_lshl_b32 s39, s29, 13
  s_add_u32 s38, s38, s39
  s_add_u32 s38, s38, 7340032
  s_min_u32 s46, s28, 26
  s_lshl_b32 s40, s46, 7
  s_lshl_b32 s41, s28, 8
  s_mul_i32 s42, s29, 655360
  s_add_u32 s41, s41, s42
  s_mul_i32 s42, s2, 4736
  s_mul_i32 s43, s28, 4736
  s_and_b32 s58, s3, 3
  s_mul_i32 s58, s58, 20
  s_mul_i32 s59, s29, 80
  s_add_u32 s58, s58, s59
  s_mul_i32 s59, s58, 3456
  s_add_u32 s59, s59, s40
  s_cmp_lt_u32 s28, 27
  s_cselect_b64 s[50:51], -1, 0
  v_cndmask_b32 v11, 0, v11, s[50:51]
  s_waitcnt lgkmcnt(0)
  s_add_u32 s44, s26, s42
  s_addc_u32 s45, s27, 0
  s_cmp_lg_u32 s3, 0
  s_cbranch_scc1 L_noclear
  v_mov_b32 v56, -1
  v_mov_b32 v57, -1
  v_mov_b32 v58, -1
  v_mov_b32 v59, -1
  v_lshlrev_b32 v60, 4, v0
  global_store_dwordx4 v60, v[56:59], s[44:45] sc1
  global_store_dwordx4 v60, v[56:59], s[44:45] offset:1024 sc1
  global_store_dwordx4 v60, v[56:59], s[44:45] offset:2048 sc1
  global_store_dwordx4 v60, v[56:59], s[44:45] offset:3072 sc1
  v_add_u32 v61, 4096, v60
  v_cmp_gt_u32 vcc, 40, v0
  s_nop 0
  s_and_saveexec_b64 s[32:33], vcc
  global_store_dwordx4 v61, v[56:59], s[44:45] sc1
  s_mov_b64 exec, s[32:33]
L_noclear:
  s_nop 4
  global_load_dwordx4 v[48:51], v9, s[4:5]
  global_load_dword v52, v9, s[4:5] offset:16
  s_add_u32 s6, s6, s38
  s_addc_u32 s7, s7, 0
  s_add_u32 s8, s8, s38
  s_addc_u32 s9, s9, 0
  s_add_u32 s10, s10, s41
  s_addc_u32 s11, s11, 0
  s_cmp_ge_u32 s3, 4
  s_cselect_b32 s56, s18, s16
  s_cselect_b32 s57, s19, s17
  s_add_u32 s56, s56, s59
  s_addc_u32 s57, s57, 0
  s_add_u32 s48, s26, s43
  s_addc_u32 s49, s27, 0
  global_load_dwordx4 v[64:67], v10, s[10:11] nt
  s_add_u32 s10, s10, 32768
  s_addc_u32 s11, s11, 0
  global_load_dwordx4 v[68:71], v10, s[10:11] nt
  s_add_u32 s10, s10, 32768
  s_addc_u32 s11, s11, 0
  s_mov_b64 s[32:33], exec
  s_mov_b64 exec, s[54:55]
  global_load_dwordx4 v[72:75], v10, s[10:11] nt
  s_mov_b64 exec, s[32:33]
  global_load_dwordx4 v[76:79], v11, s[56:57] nt
  s_add_u32 s56, s56, 27648
  s_addc_u32 s57, s57, 0
  global_load_dwordx4 v[80:83], v11, s[56:57] nt
  s_add_u32 s56, s56, 27648
  s_addc_u32 s57, s57, 0
  s_mov_b64 s[32:33], exec
  s_mov_b64 exec, s[36:37]
  global_load_dwordx4 v[84:87], v11, s[56:57] nt
  s_mov_b64 exec, s[32:33]
  s_waitcnt vmcnt(6)
  s_cmp_lg_u32 s3, 0
  s_cbranch_scc1 L_nosig
  v_mov_b32 v57, 1
  s_lshl_b32 s38, s28, 2
  v_mov_b32 v58, s38
  v_cmp_eq_u32 vcc, 0, v0
  s_nop 0
  s_and_saveexec_b64 s[32:33], vcc
  global_atomic_add v58, v57, s[24:25] sc1
  s_mov_b64 exec, s[32:33]
L_nosig:
  s_nop 4
  v_lshlrev_b32 v24, 16, v48
  v_and_b32 v32, 0xffff0000, v48
  v_lshlrev_b32 v25, 16, v49
  v_and_b32 v33, 0xffff0000, v49
  v_lshlrev_b32 v26, 16, v50
  v_and_b32 v34, 0xffff0000, v50
  v_lshlrev_b32 v27, 16, v51
  v_and_b32 v35, 0xffff0000, v51
  v_lshlrev_b32 v28, 16, v52
  v_and_b32 v36, 0xffff0000, v52
  v_add_f32 v53, v24, v32
  v_add_f32 v54, v25, v33
  v_add_f32 v55, v26, v34
  v_add_f32 v56, v27, v35
  v_add_f32 v57, v28, v36
  v_add_f32 v53, v53, v54
  v_add_f32 v55, v55, v56
  v_add_f32 v53, v53, v57
  v_add_f32 v53, v53, v55
  s_nop 1
  v_add_f32_dpp v53, v53, v53 row_ror:8 row_mask:0xf bank_mask:0xf
  s_nop 1
  v_add_f32_dpp v53, v53, v53 row_ror:4 row_mask:0xf bank_mask:0xf
  s_nop 1
  v_add_f32_dpp v53, v53, v53 row_ror:2 row_mask:0xf bank_mask:0xf
  s_nop 1
  v_add_f32_dpp v53, v53, v53 row_ror:1 row_mask:0xf bank_mask:0xf
  v_mov_b32 v54, v53
  s_nop 1
  v_permlane32_swap_b32 v53, v54
  v_add_f32 v53, v53, v54
  v_mov_b32 v54, v53
  s_nop 1
  v_permlane16_swap_b32 v53, v54
  v_add_f32 v53, v53, v54
  v_mul_f32 v53, 0x3acccccd, v53
  v_sub_f32 v55, v24, v53
  v_mul_f32 v54, v55, v55
  v_sub_f32 v55, v25, v53
  v_fmac_f32 v54, v55, v55
  v_sub_f32 v55, v26, v53
  v_fmac_f32 v54, v55, v55
  v_sub_f32 v55, v27, v53
  v_fmac_f32 v54, v55, v55
  v_sub_f32 v55, v28, v53
  v_fmac_f32 v54, v55, v55
  v_sub_f32 v55, v32, v53
  v_fmac_f32 v54, v55, v55
  v_sub_f32 v55, v33, v53
  v_fmac_f32 v54, v55, v55
  v_sub_f32 v55, v34, v53
  v_fmac_f32 v54, v55, v55
  v_sub_f32 v55, v35, v53
  v_fmac_f32 v54, v55, v55
  v_sub_f32 v55, v36, v53
  v_fmac_f32 v54, v55, v55
  s_nop 1
  v_add_f32_dpp v54, v54, v54 row_ror:8 row_mask:0xf bank_mask:0xf
  s_nop 1
  v_add_f32_dpp v54, v54, v54 row_ror:4 row_mask:0xf bank_mask:0xf
  s_nop 1
  v_add_f32_dpp v54, v54, v54 row_ror:2 row_mask:0xf bank_mask:0xf
  s_nop 1
  v_add_f32_dpp v54, v54, v54 row_ror:1 row_mask:0xf bank_mask:0xf
  v_mov_b32 v55, v54
  s_nop 1
  v_permlane32_swap_b32 v54, v55
  v_add_f32 v54, v54, v55
  v_mov_b32 v55, v54
  s_nop 1
  v_permlane16_swap_b32 v54, v55
  v_add_f32 v54, v54, v55
  v_mul_f32 v54, 0x3acccccd, v54
  v_cvt_pk_bf16_f32 v53, 0, v53
  v_cvt_pk_bf16_f32 v54, 0, v54
  v_add_f32 v54, 0x3727c5ac, v54
  v_cvt_pk_bf16_f32 v54, 0, v54
  v_sqrt_f32 v55, v54
  v_rcp_f32 v56, v55
  v_fma_f32 v57, -v55, v55, v54
  v_mul_f32 v56, 0.5, v56
  v_fma_f32 v55, v57, v56, v55
  v_cvt_pk_bf16_f32 v55, 0, v55
  v_rcp_f32 v56, v55
  v_sub_f32 v24, v24, v53
  v_sub_f32 v25, v25, v53
  v_sub_f32 v26, v26, v53
  v_sub_f32 v27, v27, v53
  v_sub_f32 v28, v28, v53
  v_sub_f32 v32, v32, v53
  v_sub_f32 v33, v33, v53
  v_sub_f32 v34, v34, v53
  v_sub_f32 v35, v35, v53
  v_sub_f32 v36, v36, v53
  v_cvt_pk_bf16_f32 v24, 0, v24
  v_cvt_pk_bf16_f32 v25, 0, v25
  v_cvt_pk_bf16_f32 v26, 0, v26
  v_cvt_pk_bf16_f32 v27, 0, v27
  v_cvt_pk_bf16_f32 v28, 0, v28
  v_cvt_pk_bf16_f32 v32, 0, v32
  v_cvt_pk_bf16_f32 v33, 0, v33
  v_cvt_pk_bf16_f32 v34, 0, v34
  v_cvt_pk_bf16_f32 v35, 0, v35
  v_cvt_pk_bf16_f32 v36, 0, v36
  v_mul_f32 v57, v24, v56
  v_fma_f32 v58, -v57, v55, v24
  v_fma_f32 v24, v58, v56, v57
  v_mul_f32 v57, v25, v56
  v_fma_f32 v58, -v57, v55, v25
  v_fma_f32 v25, v58, v56, v57
  v_mul_f32 v57, v26, v56
  v_fma_f32 v58, -v57, v55, v26
  v_fma_f32 v26, v58, v56, v57
  v_mul_f32 v57, v27, v56
  v_fma_f32 v58, -v57, v55, v27
  v_fma_f32 v27, v58, v56, v57
  v_mul_f32 v57, v28, v56
  v_fma_f32 v58, -v57, v55, v28
  v_fma_f32 v28, v58, v56, v57
  v_mul_f32 v57, v32, v56
  v_fma_f32 v58, -v57, v55, v32
  v_fma_f32 v32, v58, v56, v57
  v_mul_f32 v57, v33, v56
  v_fma_f32 v58, -v57, v55, v33
  v_fma_f32 v33, v58, v56, v57
  v_mul_f32 v57, v34, v56
  v_fma_f32 v58, -v57, v55, v34
  v_fma_f32 v34, v58, v56, v57
  v_mul_f32 v57, v35, v56
  v_fma_f32 v58, -v57, v55, v35
  v_fma_f32 v35, v58, v56, v57
  v_mul_f32 v57, v36, v56
  v_fma_f32 v58, -v57, v55, v36
  v_fma_f32 v36, v58, v56, v57
  v_cvt_pk_bf16_f32 v48, v24, v32
  v_cvt_pk_bf16_f32 v49, v25, v33
  v_cvt_pk_bf16_f32 v50, v26, v34
  v_cvt_pk_bf16_f32 v51, v27, v35
  v_cvt_pk_bf16_f32 v52, v28, v36
  ds_write_b32 v9, v48 offset:0
  ds_write_b32 v9, v49 offset:4
  ds_write_b32 v9, v50 offset:8
  ds_write_b32 v9, v51 offset:12
  ds_write_b32 v9, v52 offset:16
  s_mul_i32 s38, s3, 20
  s_mul_i32 s39, s29, 160
  s_add_u32 s38, s38, s39
  v_lshlrev_b32 v5, 3, v3
  v_lshl_add_u32 v5, v15, 1, v5
  v_add_u32 v5, s38, v5
  ds_read_u16 v12, v5 offset:0
  s_lshl_b32 s38, s58, 1
  v_lshrrev_b32 v6, 3, v0
  v_lshl_add_u32 v6, v6, 1, s38
  ds_read_u16 v17, v6 offset:0
  ds_read_u16 v19, v6 offset:16
  ds_read_u16 v21, v6 offset:32
  v_mov_b32 v24, 0
  v_mov_b32 v25, 0
  v_mov_b32 v26, 0
  v_mov_b32 v27, 0
  v_mov_b32 v28, 0
  v_mov_b32 v29, 0
  v_mov_b32 v30, 0
  v_mov_b32 v31, 0
  v_mov_b32 v32, 0
  v_mov_b32 v33, 0
  v_mov_b32 v34, 0
  v_mov_b32 v35, 0
  v_mov_b32 v36, 0
  v_mov_b32 v37, 0
  v_mov_b32 v38, 0
  v_mov_b32 v39, 0
  s_waitcnt lgkmcnt(0)
  v_lshlrev_b32 v13, 16, v12
  v_lshlrev_b32 v18, 16, v17
  v_lshlrev_b32 v20, 16, v19
  v_lshlrev_b32 v22, 16, v21
  s_waitcnt vmcnt(5)
  v_dot2c_f32_bf16_dpp v24, v12, v64 row_newbcast:0 row_mask:0xf bank_mask:0xf
  v_dot2c_f32_bf16_dpp v25, v13, v64 row_newbcast:0 row_mask:0xf bank_mask:0xf
  v_dot2c_f32_bf16_dpp v26, v12, v65 row_newbcast:0 row_mask:0xf bank_mask:0xf
  v_dot2c_f32_bf16_dpp v27, v13, v65 row_newbcast:0 row_mask:0xf bank_mask:0xf
  v_dot2c_f32_bf16_dpp v28, v12, v66 row_newbcast:0 row_mask:0xf bank_mask:0xf
  v_dot2c_f32_bf16_dpp v29, v13, v66 row_newbcast:0 row_mask:0xf bank_mask:0xf
  v_dot2c_f32_bf16_dpp v30, v12, v67 row_newbcast:0 row_mask:0xf bank_mask:0xf
  v_dot2c_f32_bf16_dpp v31, v13, v67 row_newbcast:0 row_mask:0xf bank_mask:0xf
  global_load_dwordx4 v[112:115], v1, s[6:7] nt
  s_add_u32 s6, s6, 65536
  s_addc_u32 s7, s7, 0
  s_waitcnt vmcnt(5)
  v_dot2c_f32_bf16_dpp v24, v12, v68 row_newbcast:1 row_mask:0xf bank_mask:0xf
  v_dot2c_f32_bf16_dpp v25, v13, v68 row_newbcast:1 row_mask:0xf bank_mask:0xf
  v_dot2c_f32_bf16_dpp v26, v12, v69 row_newbcast:1 row_mask:0xf bank_mask:0xf
  v_dot2c_f32_bf16_dpp v27, v13, v69 row_newbcast:1 row_mask:0xf bank_mask:0xf
  v_dot2c_f32_bf16_dpp v28, v12, v70 row_newbcast:1 row_mask:0xf bank_mask:0xf
  v_dot2c_f32_bf16_dpp v29, v13, v70 row_newbcast:1 row_mask:0xf bank_mask:0xf
  v_dot2c_f32_bf16_dpp v30, v12, v71 row_newbcast:1 row_mask:0xf bank_mask:0xf
  v_dot2c_f32_bf16_dpp v31, v13, v71 row_newbcast:1 row_mask:0xf bank_mask:0xf
  global_load_dwordx4 v[116:119], v1, s[6:7] nt
  s_add_u32 s6, s6, 65536
  s_addc_u32 s7, s7, 0
  s_waitcnt vmcnt(5)
  s_mov_b64 s[32:33], exec
  s_mov_b64 exec, s[54:55]
  v_dot2c_f32_bf16_dpp v24, v12, v72 row_newbcast:2 row_mask:0xf bank_mask:0xf
  v_dot2c_f32_bf16_dpp v25, v13, v72 row_newbcast:2 row_mask:0xf bank_mask:0xf
  v_dot2c_f32_bf16_dpp v26, v12, v73 row_newbcast:2 row_mask:0xf bank_mask:0xf
  v_dot2c_f32_bf16_dpp v27, v13, v73 row_newbcast:2 row_mask:0xf bank_mask:0xf
  v_dot2c_f32_bf16_dpp v28, v12, v74 row_newbcast:2 row_mask:0xf bank_mask:0xf
  v_dot2c_f32_bf16_dpp v29, v13, v74 row_newbcast:2 row_mask:0xf bank_mask:0xf
  v_dot2c_f32_bf16_dpp v30, v12, v75 row_newbcast:2 row_mask:0xf bank_mask:0xf
  v_dot2c_f32_bf16_dpp v31, v13, v75 row_newbcast:2 row_mask:0xf bank_mask:0xf
  s_mov_b64 exec, s[32:33]
  global_load_dwordx4 v[120:123], v1, s[6:7] nt
  s_add_u32 s6, s6, 65536
  s_addc_u32 s7, s7, 0
  v_permlane32_swap_b32 v24, v28
  v_permlane32_swap_b32 v25, v29
  v_permlane32_swap_b32 v26, v30
  v_permlane32_swap_b32 v27, v31
  v_add_f32 v24, v24, v28
  v_add_f32 v25, v25, v29
  v_add_f32 v26, v26, v30
  v_add_f32 v27, v27, v31
  s_nop 0
  v_permlane16_swap_b32 v24, v26
  v_permlane16_swap_b32 v25, v27
  v_add_f32 v24, v24, v26
  v_add_f32 v25, v25, v27
  v_lshlrev_b32 v4, 5, v3
  v_lshl_add_u32 v4, v15, 3, v4
  s_mul_i32 s38, s3, 784
  v_add_u32 v5, s38, v4
  ds_write_b64 v5, v[24:25] offset:1280
  s_waitcnt vmcnt(5)
  v_dot2c_f32_bf16 v32, v17, v76
  v_dot2c_f32_bf16 v33, v18, v76
  v_dot2c_f32_bf16 v34, v17, v77
  v_dot2c_f32_bf16 v35, v18, v77
  v_dot2c_f32_bf16 v36, v17, v78
  v_dot2c_f32_bf16 v37, v18, v78
  v_dot2c_f32_bf16 v38, v17, v79
  v_dot2c_f32_bf16 v39, v18, v79
  global_load_dwordx4 v[124:127], v1, s[6:7] nt
  s_add_u32 s6, s6, 65536
  s_addc_u32 s7, s7, 0
  s_waitcnt vmcnt(5)
  v_dot2c_f32_bf16 v32, v19, v80
  v_dot2c_f32_bf16 v33, v20, v80
  v_dot2c_f32_bf16 v34, v19, v81
  v_dot2c_f32_bf16 v35, v20, v81
  v_dot2c_f32_bf16 v36, v19, v82
  v_dot2c_f32_bf16 v37, v20, v82
  v_dot2c_f32_bf16 v38, v19, v83
  v_dot2c_f32_bf16 v39, v20, v83
  global_load_dwordx4 v[128:131], v1, s[6:7] nt
  s_add_u32 s6, s6, 65536
  s_addc_u32 s7, s7, 0
  s_waitcnt vmcnt(5)
  s_mov_b64 s[32:33], exec
  s_mov_b64 exec, s[36:37]
  v_dot2c_f32_bf16 v32, v21, v84
  v_dot2c_f32_bf16 v33, v22, v84
  v_dot2c_f32_bf16 v34, v21, v85
  v_dot2c_f32_bf16 v35, v22, v85
  v_dot2c_f32_bf16 v36, v21, v86
  v_dot2c_f32_bf16 v37, v22, v86
  v_dot2c_f32_bf16 v38, v21, v87
  v_dot2c_f32_bf16 v39, v22, v87
  s_mov_b64 exec, s[32:33]
  global_load_dwordx4 v[132:135], v1, s[6:7] nt
  s_add_u32 s6, s6, 65536
  s_addc_u32 s7, s7, 0
  v_permlane32_swap_b32 v32, v36
  v_permlane32_swap_b32 v33, v37
  v_permlane32_swap_b32 v34, v38
  v_permlane32_swap_b32 v35, v39
  v_add_f32 v32, v32, v36
  v_add_f32 v33, v33, v37
  v_add_f32 v34, v34, v38
  v_add_f32 v35, v35, v39
  s_nop 0
  v_permlane16_swap_b32 v32, v34
  v_permlane16_swap_b32 v33, v35
  v_add_f32 v32, v32, v34
  v_add_f32 v33, v33, v35
  s_nop 0
  v_add_f32_dpp v32, v32, v32 row_ror:8 row_mask:0xf bank_mask:0x3
  s_nop 1
  v_add_f32_dpp v32, v33, v33 row_ror:8 row_mask:0xf bank_mask:0xc
  v_and_b32 v5, 7, v0
  v_lshlrev_b32 v5, 5, v5
  v_lshrrev_b32 v6, 5, v0
  v_lshl_add_u32 v5, v6, 4, v5
  v_bfe_u32 v6, v0, 4, 1
  v_lshl_add_u32 v5, v6, 3, v5
  v_bfe_u32 v6, v0, 3, 1
  v_lshl_add_u32 v5, v6, 2, v5
  s_mul_i32 s38, s3, 784
  v_add_u32 v5, s38, v5
  ds_write_b32 v5, v32 offset:1792
  ds_write_b32 v97, v97 offset:8256
  s_cmp_lg_u32 s3, 0
  s_cbranch_scc1 L_noec
  v_and_b32 v8, 31, v0
  v_lshlrev_b32 v8, 2, v8
  global_load_dword v96, v8, s[24:25] sc1
L_noec:
  s_nop 4
  s_waitcnt lgkmcnt(0)
  s_barrier
  v_and_b32 v6, 31, v0
  v_lshrrev_b32 v7, 5, v0
  s_cmp_ge_u32 s3, 4
  s_cbranch_scc1 L_glupub
  v_mul_u32_u24 v7, 3136, v7
  v_lshl_add_u32 v7, v6, 2, v7
  s_lshl_b32 s38, s3, 7
  v_add_u32 v7, s38, v7
  ds_read_b32 v48, v7 offset:1280
  ds_read_b32 v49, v7 offset:2064
  ds_read_b32 v50, v7 offset:2848
  ds_read_b32 v51, v7 offset:3632
  s_add_u32 s38, s38, 1536
  v_lshl_add_u32 v6, v6, 2, s38
  s_waitcnt lgkmcnt(0)
  v_add_f32 v48, v48, v49
  v_add_f32 v50, v50, v51
  v_add_f32 v48, v48, v50
  s_branch L_pub0
L_glupub:
  s_nop 4
  v_mul_u32_u24 v7, 1568, v7
  v_lshl_add_u32 v7, v6, 2, v7
  s_and_b32 s38, s3, 1
  s_lshl_b32 s38, s38, 7
  s_bfe_u32 s39, s3, 0x10001
  s_mul_i32 s40, s39, 3136
  s_add_u32 s40, s40, s38
  v_add_u32 v7, s40, v7
  ds_read_b32 v48, v7 offset:1792
  ds_read_b32 v49, v7 offset:2576
  s_lshl_b32 s39, s39, 8
  s_add_u32 s39, s39, s38
  s_add_u32 s39, s39, 1024
  v_lshl_add_u32 v6, v6, 2, s39
  s_waitcnt lgkmcnt(0)
  v_add_f32 v48, v48, v49
L_pub0:
  s_nop 4
  v_mov_b32 v49, v48
  s_nop 1
  v_permlane32_swap_b32 v48, v49
  v_add_f32 v48, v48, v49
  v_min_u32 v48, 0xfffffffe, v48
  s_mov_b64 s[32:33], exec
  s_mov_b64 exec, s[54:55]
  global_store_dword v6, v48, s[44:45] sc1
  global_store_dword v6, v48, s[44:45] offset:2688
  s_mov_b64 exec, s[32:33]
  s_lshl_b32 s38, s3, 4
  v_lshl_add_u32 v98, v15, 1, s38
  s_movk_i32 s39, 1280
  v_mul_lo_u32 v98, v98, s39
  v_lshl_add_u32 v98, v3, 4, v98
  s_lshl_b32 s38, s3, 3
  v_lshl_add_u32 v2, v15, 1, s38
  v_mul_lo_u32 v99, v2, s39
  v_lshl_add_u32 v99, v3, 4, v99
  v_cndmask_b32 v99, 0, v99, s[50:51]
  s_mul_i32 s38, s28, 163840
  s_mul_i32 s40, s29, 160
  s_add_u32 s38, s38, s40
  s_add_u32 s12, s12, s38
  s_addc_u32 s13, s13, 0
  s_mul_i32 s38, s46, 81920
  s_add_u32 s38, s38, s40
  s_add_u32 s20, s20, s38
  s_addc_u32 s21, s21, 0
  s_add_u32 s14, s12, 10240
  s_addc_u32 s15, s13, 0
  v_lshrrev_b32 v92, 5, v0
  v_mul_u32_u24 v92, 151552, v92
  v_and_b32 v8, 31, v0
  v_lshl_add_u32 v92, v8, 4, v92
  v_add_u32 v93, 303104, v92
  v_add_u32 v94, 606208, v92
  v_add_u32 v95, 909312, v92
  v_lshlrev_b32 v8, 2, v8
  s_cmp_eq_u32 s3, 0
  s_cselect_b32 s58, 0, 2
  s_add_u32 s42, s48, 2688
  s_addc_u32 s43, s49, 0
  s_waitcnt vmcnt(6)
  s_waitcnt vmcnt(5)
  global_load_dwordx4 v[136:139], v1, s[6:7] nt
  s_add_u32 s6, s6, 65536
  s_addc_u32 s7, s7, 0
  s_waitcnt vmcnt(5)
  global_load_dwordx4 v[140:143], v1, s[6:7] nt
  s_add_u32 s6, s6, 65536
  s_addc_u32 s7, s7, 0
  s_waitcnt vmcnt(5)
  global_load_dwordx4 v[144:147], v1, s[6:7] nt
  s_add_u32 s6, s6, 65536
  s_addc_u32 s7, s7, 0
  s_waitcnt vmcnt(5)
  global_load_dwordx4 v[148:151], v1, s[6:7] nt
  s_add_u32 s6, s6, 65536
  s_addc_u32 s7, s7, 0
  s_waitcnt vmcnt(5)
  global_load_dwordx4 v[152:155], v1, s[6:7] nt
  s_add_u32 s6, s6, 65536
  s_addc_u32 s7, s7, 0
  s_waitcnt vmcnt(4)
  s_cmp_ge_u32 s58, 2
  s_cbranch_scc1 L_ck0_skip
  s_cmp_eq_u32 s58, 1
  s_cbranch_scc1 L_ck0_data
  v_readlane_b32 s38, v96, s28
  s_nop 0
  s_cmp_ge_u32 s38, 8
  s_cbranch_scc1 L_ck0_cntok
  global_load_dword v96, v8, s[24:25] sc1
  s_branch L_ck0_skip
L_ck0_data:
  s_nop 4
  v_max3_u32 v100, v48, v49, v50
  v_max3_u32 v101, v51, v52, v53
  v_max3_u32 v100, v100, v54, v55
  v_max3_u32 v101, v101, v56, v57
  v_max3_u32 v100, v100, v58, v59
  v_max3_u32 v101, v101, v60, v61
  v_max3_u32 v100, v100, v62, v63
  v_max3_u32 v101, v101, v240, v241
  v_max3_u32 v100, v100, v242, v243
  v_max3_u32 v101, v101, v244, v245
  v_max3_u32 v100, v100, v246, v247
  v_max3_u32 v101, v101, v248, v249
  v_max3_u32 v100, v100, v250, v251
  v_max3_u32 v101, v101, v252, v253
  v_max3_u32 v100, v100, v254, v255
  v_max_u32 v100, v100, v101
  v_cmp_eq_u32 vcc, -1, v100
  s_nop 0
  s_cbranch_vccnz L_ck0_cntok
  s_mov_b32 s58, 3
  s_branch L_ck0_skip
L_ck0_cntok:
  s_nop 4
  s_mov_b32 s58, 1
  global_load_dwordx4 v[48:51], v92, s[42:43] offset:1536 sc1
  global_load_dwordx4 v[52:55], v93, s[42:43] offset:1536 sc1
  global_load_dwordx4 v[56:59], v94, s[42:43] offset:1536 sc1
  global_load_dwordx4 v[60:63], v95, s[42:43] offset:1536 sc1
  global_load_dwordx4 v[240:243], v92, s[42:43] offset:1024 sc1
  global_load_dwordx4 v[244:247], v93, s[42:43] offset:1024 sc1
  global_load_dwordx4 v[248:251], v94, s[42:43] offset:1024 sc1
  global_load_dwordx4 v[252:255], v95, s[42:43] offset:1024 sc1
L_ck0_skip:
  s_nop 4
  global_load_dwordx4 v[156:159], v1, s[6:7] nt
  s_add_u32 s6, s6, 65536
  s_addc_u32 s7, s7, 0
  global_load_dwordx4 v[160:163], v1, s[6:7] nt
  s_add_u32 s6, s6, 65536
  s_addc_u32 s7, s7, 0
  s_waitcnt vmcnt(5)
  global_load_dwordx4 v[164:167], v1, s[6:7] nt
  s_add_u32 s6, s6, 65536
  s_addc_u32 s7, s7, 0
  s_waitcnt vmcnt(5)
  global_load_dwordx4 v[168:171], v1, s[6:7] nt
  s_add_u32 s6, s6, 65536
  s_addc_u32 s7, s7, 0
  s_waitcnt vmcnt(5)
  global_load_dwordx4 v[172:175], v1, s[6:7] nt
  s_waitcnt vmcnt(5)
  global_load_dwordx4 v[176:179], v1, s[8:9] nt
  s_add_u32 s8, s8, 65536
  s_addc_u32 s9, s9, 0
  s_waitcnt vmcnt(5)
  s_cmp_ge_u32 s58, 2
  s_cbranch_scc1 L_ck1_skip
  s_cmp_eq_u32 s58, 1
  s_cbranch_scc1 L_ck1_data
  v_readlane_b32 s38, v96, s28
  s_nop 0
  s_cmp_ge_u32 s38, 8
  s_cbranch_scc1 L_ck1_cntok
  global_load_dword v96, v8, s[24:25] sc1
  s_branch L_ck1_skip
L_ck1_data:
  s_nop 4
  v_max3_u32 v100, v48, v49, v50
  v_max3_u32 v101, v51, v52, v53
  v_max3_u32 v100, v100, v54, v55
  v_max3_u32 v101, v101, v56, v57
  v_max3_u32 v100, v100, v58, v59
  v_max3_u32 v101, v101, v60, v61
  v_max3_u32 v100, v100, v62, v63
  v_max3_u32 v101, v101, v240, v241
  v_max3_u32 v100, v100, v242, v243
  v_max3_u32 v101, v101, v244, v245
  v_max3_u32 v100, v100, v246, v247
  v_max3_u32 v101, v101, v248, v249
  v_max3_u32 v100, v100, v250, v251
  v_max3_u32 v101, v101, v252, v253
  v_max3_u32 v100, v100, v254, v255
  v_max_u32 v100, v100, v101
  v_cmp_eq_u32 vcc, -1, v100
  s_nop 0
  s_cbranch_vccnz L_ck1_cntok
  s_mov_b32 s58, 3
  s_branch L_ck1_skip
L_ck1_cntok:
  s_nop 4
  s_mov_b32 s58, 1
  global_load_dwordx4 v[48:51], v92, s[42:43] offset:1536 sc1
  global_load_dwordx4 v[52:55], v93, s[42:43] offset:1536 sc1
  global_load_dwordx4 v[56:59], v94, s[42:43] offset:1536 sc1
  global_load_dwordx4 v[60:63], v95, s[42:43] offset:1536 sc1
  global_load_dwordx4 v[240:243], v92, s[42:43] offset:1024 sc1
  global_load_dwordx4 v[244:247], v93, s[42:43] offset:1024 sc1
  global_load_dwordx4 v[248:251], v94, s[42:43] offset:1024 sc1
  global_load_dwordx4 v[252:255], v95, s[42:43] offset:1024 sc1
L_ck1_skip:
  s_nop 4
  global_load_dwordx4 v[180:183], v1, s[8:9] nt
  s_add_u32 s8, s8, 65536
  s_addc_u32 s9, s9, 0
  s_waitcnt vmcnt(5)
  global_load_dwordx4 v[184:187], v1, s[8:9] nt
  s_add_u32 s8, s8, 65536
  s_addc_u32 s9, s9, 0
  s_waitcnt vmcnt(5)
  global_load_dwordx4 v[188:191], v1, s[8:9] nt
  s_add_u32 s8, s8, 65536
  s_addc_u32 s9, s9, 0
  s_waitcnt vmcnt(5)
  global_load_dwordx4 v[192:195], v1, s[8:9] nt
  s_add_u32 s8, s8, 65536
  s_addc_u32 s9, s9, 0
  ds_read_b32 v102, v97 offset:8256
  s_waitcnt vmcnt(5)
  global_load_dwordx4 v[196:199], v1, s[8:9] nt
  s_add_u32 s8, s8, 65536
  s_addc_u32 s9, s9, 0
  s_mov_b32 s59, 28
  s_cmp_eq_u32 s58, 3
  s_cbranch_scc1 L_pqok
  s_waitcnt lgkmcnt(0)
  v_readfirstlane_b32 s38, v102
  s_nop 0
  s_cmp_eq_u32 s38, 1
  s_cbranch_scc1 L_b2
  ds_read_b32 v102, v97 offset:8256
  s_waitcnt vmcnt(5)
  global_load_dwordx4 v[200:203], v1, s[8:9] nt
  s_add_u32 s8, s8, 65536
  s_addc_u32 s9, s9, 0
  s_mov_b32 s59, 29
  s_cmp_eq_u32 s58, 3
  s_cbranch_scc1 L_pqok
  s_waitcnt lgkmcnt(0)
  v_readfirstlane_b32 s38, v102
  s_nop 0
  s_cmp_eq_u32 s38, 1
  s_cbranch_scc1 L_b2
  ds_read_b32 v102, v97 offset:8256
  s_waitcnt vmcnt(5)
  s_cmp_ge_u32 s58, 2
  s_cbranch_scc1 L_ck2_skip
  s_cmp_eq_u32 s58, 1
  s_cbranch_scc1 L_ck2_data
  v_readlane_b32 s38, v96, s28
  s_nop 0
  s_cmp_ge_u32 s38, 8
  s_cbranch_scc1 L_ck2_cntok
  global_load_dword v96, v8, s[24:25] sc1
  s_branch L_ck2_skip
L_ck2_data:
  s_nop 4
  v_max3_u32 v100, v48, v49, v50
  v_max3_u32 v101, v51, v52, v53
  v_max3_u32 v100, v100, v54, v55
  v_max3_u32 v101, v101, v56, v57
  v_max3_u32 v100, v100, v58, v59
  v_max3_u32 v101, v101, v60, v61
  v_max3_u32 v100, v100, v62, v63
  v_max3_u32 v101, v101, v240, v241
  v_max3_u32 v100, v100, v242, v243
  v_max3_u32 v101, v101, v244, v245
  v_max3_u32 v100, v100, v246, v247
  v_max3_u32 v101, v101, v248, v249
  v_max3_u32 v100, v100, v250, v251
  v_max3_u32 v101, v101, v252, v253
  v_max3_u32 v100, v100, v254, v255
  v_max_u32 v100, v100, v101
  v_cmp_eq_u32 vcc, -1, v100
  s_nop 0
  s_cbranch_vccnz L_ck2_cntok
  s_mov_b32 s58, 3
  s_branch L_ck2_skip
L_ck2_cntok:
  s_nop 4
  s_mov_b32 s58, 1
  global_load_dwordx4 v[48:51], v92, s[42:43] offset:1536 sc1
  global_load_dwordx4 v[52:55], v93, s[42:43] offset:1536 sc1
  global_load_dwordx4 v[56:59], v94, s[42:43] offset:1536 sc1
  global_load_dwordx4 v[60:63], v95, s[42:43] offset:1536 sc1
  global_load_dwordx4 v[240:243], v92, s[42:43] offset:1024 sc1
  global_load_dwordx4 v[244:247], v93, s[42:43] offset:1024 sc1
  global_load_dwordx4 v[248:251], v94, s[42:43] offset:1024 sc1
  global_load_dwordx4 v[252:255], v95, s[42:43] offset:1024 sc1
L_ck2_skip:
  s_nop 4
  global_load_dwordx4 v[204:207], v1, s[8:9] nt
  s_add_u32 s8, s8, 65536
  s_addc_u32 s9, s9, 0
  s_mov_b32 s59, 30
  s_cmp_eq_u32 s58, 3
  s_cbranch_scc1 L_pqok
  s_waitcnt lgkmcnt(0)
  v_readfirstlane_b32 s38, v102
  s_nop 0
  s_cmp_eq_u32 s38, 1
  s_cbranch_scc1 L_b2
  ds_read_b32 v102, v97 offset:8256
  s_waitcnt vmcnt(5)
  global_load_dwordx4 v[208:211], v1, s[8:9] nt
  s_add_u32 s8, s8, 65536
  s_addc_u32 s9, s9, 0
  s_mov_b32 s59, 31
  s_cmp_eq_u32 s58, 3
  s_cbranch_scc1 L_pqok
  s_waitcnt lgkmcnt(0)
  v_readfirstlane_b32 s38, v102
  s_nop 0
  s_cmp_eq_u32 s38, 1
  s_cbranch_scc1 L_b2
  ds_read_b32 v102, v97 offset:8256
  s_waitcnt vmcnt(5)
  global_load_dwordx4 v[212:215], v1, s[8:9] nt
  s_add_u32 s8, s8, 65536
  s_addc_u32 s9, s9, 0
  s_mov_b32 s59, 32
  s_cmp_eq_u32 s58, 3
  s_cbranch_scc1 L_pqok
  s_waitcnt lgkmcnt(0)
  v_readfirstlane_b32 s38, v102
  s_nop 0
  s_cmp_eq_u32 s38, 1
  s_cbranch_scc1 L_b2
  ds_read_b32 v102, v97 offset:8256
  s_waitcnt vmcnt(5)
  global_load_dwordx4 v[216:219], v1, s[8:9] nt
  s_add_u32 s8, s8, 65536
  s_addc_u32 s9, s9, 0
  s_mov_b32 s59, 33
  s_cmp_eq_u32 s58, 3
  s_cbranch_scc1 L_pqok
  s_waitcnt lgkmcnt(0)
  v_readfirstlane_b32 s38, v102
  s_nop 0
  s_cmp_eq_u32 s38, 1
  s_cbranch_scc1 L_b2
  ds_read_b32 v102, v97 offset:8256
  s_waitcnt vmcnt(5)
  global_load_dwordx4 v[220:223], v1, s[8:9] nt
  s_add_u32 s8, s8, 65536
  s_addc_u32 s9, s9, 0
  s_mov_b32 s59, 34
  s_cmp_eq_u32 s58, 3
  s_cbranch_scc1 L_pqok
  s_waitcnt lgkmcnt(0)
  v_readfirstlane_b32 s38, v102
  s_nop 0
  s_cmp_eq_u32 s38, 1
  s_cbranch_scc1 L_b2
  ds_read_b32 v102, v97 offset:8256
  s_waitcnt vmcnt(5)
  global_load_dwordx4 v[224:227], v1, s[8:9] nt
  s_add_u32 s8, s8, 65536
  s_addc_u32 s9, s9, 0
  s_mov_b32 s59, 35
  s_cmp_eq_u32 s58, 3
  s_cbranch_scc1 L_pqok
  s_waitcnt lgkmcnt(0)
  v_readfirstlane_b32 s38, v102
  s_nop 0
  s_cmp_eq_u32 s38, 1
  s_cbranch_scc1 L_b2
  s_waitcnt vmcnt(5)
  s_cmp_ge_u32 s58, 2
  s_cbranch_scc1 L_ck3_skip
  s_cmp_eq_u32 s58, 1
  s_cbranch_scc1 L_ck3_data
  v_readlane_b32 s38, v96, s28
  s_nop 0
  s_cmp_ge_u32 s38, 8
  s_cbranch_scc1 L_ck3_cntok
  global_load_dword v96, v8, s[24:25] sc1
  s_branch L_ck3_skip
L_ck3_data:
  s_nop 4
  v_max3_u32 v100, v48, v49, v50
  v_max3_u32 v101, v51, v52, v53
  v_max3_u32 v100, v100, v54, v55
  v_max3_u32 v101, v101, v56, v57
  v_max3_u32 v100, v100, v58, v59
  v_max3_u32 v101, v101, v60, v61
  v_max3_u32 v100, v100, v62, v63
  v_max3_u32 v101, v101, v240, v241
  v_max3_u32 v100, v100, v242, v243
  v_max3_u32 v101, v101, v244, v245
  v_max3_u32 v100, v100, v246, v247
  v_max3_u32 v101, v101, v248, v249
  v_max3_u32 v100, v100, v250, v251
  v_max3_u32 v101, v101, v252, v253
  v_max3_u32 v100, v100, v254, v255
  v_max_u32 v100, v100, v101
  v_cmp_eq_u32 vcc, -1, v100
  s_nop 0
  s_cbranch_vccnz L_ck3_cntok
  s_mov_b32 s58, 3
  s_branch L_ck3_skip
L_ck3_cntok:
  s_nop 4
  s_mov_b32 s58, 1
  global_load_dwordx4 v[48:51], v92, s[42:43] offset:1536 sc1
  global_load_dwordx4 v[52:55], v93, s[42:43] offset:1536 sc1
  global_load_dwordx4 v[56:59], v94, s[42:43] offset:1536 sc1
  global_load_dwordx4 v[60:63], v95, s[42:43] offset:1536 sc1
  global_load_dwordx4 v[240:243], v92, s[42:43] offset:1024 sc1
  global_load_dwordx4 v[244:247], v93, s[42:43] offset:1024 sc1
  global_load_dwordx4 v[248:251], v94, s[42:43] offset:1024 sc1
  global_load_dwordx4 v[252:255], v95, s[42:43] offset:1024 sc1
L_ck3_skip:
  s_nop 4
  global_load_dwordx4 v[228:231], v1, s[8:9] nt
  s_add_u32 s8, s8, 65536
  s_addc_u32 s9, s9, 0
  s_mov_b32 s59, 36
  s_cmp_lg_u32 s3, 0
  s_cbranch_scc1 L_flagspin
  s_cmp_eq_u32 s58, 3
  s_cbranch_scc1 L_pqok
  s_waitcnt vmcnt(1)
  s_cmp_ge_u32 s58, 2
  s_cbranch_scc1 L_ck4_skip
  s_cmp_eq_u32 s58, 1
  s_cbranch_scc1 L_ck4_data
  v_readlane_b32 s38, v96, s28
  s_nop 0
  s_cmp_ge_u32 s38, 8
  s_cbranch_scc1 L_ck4_cntok
  global_load_dword v96, v8, s[24:25] sc1
  s_branch L_ck4_skip
L_ck4_data:
  s_nop 4
  v_max3_u32 v100, v48, v49, v50
  v_max3_u32 v101, v51, v52, v53
  v_max3_u32 v100, v100, v54, v55
  v_max3_u32 v101, v101, v56, v57
  v_max3_u32 v100, v100, v58, v59
  v_max3_u32 v101, v101, v60, v61
  v_max3_u32 v100, v100, v62, v63
  v_max3_u32 v101, v101, v240, v241
  v_max3_u32 v100, v100, v242, v243
  v_max3_u32 v101, v101, v244, v245
  v_max3_u32 v100, v100, v246, v247
  v_max3_u32 v101, v101, v248, v249
  v_max3_u32 v100, v100, v250, v251
  v_max3_u32 v101, v101, v252, v253
  v_max3_u32 v100, v100, v254, v255
  v_max_u32 v100, v100, v101
  v_cmp_eq_u32 vcc, -1, v100
  s_nop 0
  s_cbranch_vccnz L_ck4_cntok
  s_mov_b32 s58, 3
  s_branch L_ck4_skip
L_ck4_cntok:
  s_nop 4
  s_mov_b32 s58, 1
  global_load_dwordx4 v[48:51], v92, s[48:49] offset:1536 sc1
  global_load_dwordx4 v[52:55], v93, s[48:49] offset:1536 sc1
  global_load_dwordx4 v[56:59], v94, s[48:49] offset:1536 sc1
  global_load_dwordx4 v[60:63], v95, s[48:49] offset:1536 sc1
  global_load_dwordx4 v[240:243], v92, s[48:49] offset:1024 sc1
  global_load_dwordx4 v[244:247], v93, s[48:49] offset:1024 sc1
  global_load_dwordx4 v[248:251], v94, s[48:49] offset:1024 sc1
  global_load_dwordx4 v[252:255], v95, s[48:49] offset:1024 sc1
L_ck4_skip:
  s_nop 4
  s_mov_b32 s47, 0
L_pqloop:
  s_nop 4
  s_cmp_eq_u32 s58, 3
  s_cbranch_scc1 L_pqok
  s_add_u32 s47, s47, 1
  s_cmp_ge_u32 s47, 200000
  s_cbranch_scc1 L_pqok
  s_waitcnt vmcnt(0)
  s_cmp_ge_u32 s58, 2
  s_cbranch_scc1 L_ck5_skip
  s_cmp_eq_u32 s58, 1
  s_cbranch_scc1 L_ck5_data
  v_readlane_b32 s38, v96, s28
  s_nop 0
  s_cmp_ge_u32 s38, 8
  s_cbranch_scc1 L_ck5_cntok
  global_load_dword v96, v8, s[24:25] sc1
  s_branch L_ck5_skip
L_ck5_data:
  s_nop 4
  v_max3_u32 v100, v48, v49, v50
  v_max3_u32 v101, v51, v52, v53
  v_max3_u32 v100, v100, v54, v55
  v_max3_u32 v101, v101, v56, v57
  v_max3_u32 v100, v100, v58, v59
  v_max3_u32 v101, v101, v60, v61
  v_max3_u32 v100, v100, v62, v63
  v_max3_u32 v101, v101, v240, v241
  v_max3_u32 v100, v100, v242, v243
  v_max3_u32 v101, v101, v244, v245
  v_max3_u32 v100, v100, v246, v247
  v_max3_u32 v101, v101, v248, v249
  v_max3_u32 v100, v100, v250, v251
  v_max3_u32 v101, v101, v252, v253
  v_max3_u32 v100, v100, v254, v255
  v_max_u32 v100, v100, v101
  v_cmp_eq_u32 vcc, -1, v100
  s_nop 0
  s_cbranch_vccnz L_ck5_cntok
  s_mov_b32 s58, 3
  s_branch L_ck5_skip
L_ck5_cntok:
  s_nop 4
  s_mov_b32 s58, 1
  global_load_dwordx4 v[48:51], v92, s[42:43] offset:1536 sc1
  global_load_dwordx4 v[52:55], v93, s[42:43] offset:1536 sc1
  global_load_dwordx4 v[56:59], v94, s[42:43] offset:1536 sc1
  global_load_dwordx4 v[60:63], v95, s[42:43] offset:1536 sc1
  global_load_dwordx4 v[240:243], v92, s[42:43] offset:1024 sc1
  global_load_dwordx4 v[244:247], v93, s[42:43] offset:1024 sc1
  global_load_dwordx4 v[248:251], v94, s[42:43] offset:1024 sc1
  global_load_dwordx4 v[252:255], v95, s[42:43] offset:1024 sc1
L_ck5_skip:
  s_nop 4
  s_waitcnt vmcnt(0)
  s_cmp_ge_u32 s58, 2
  s_cbranch_scc1 L_ck6_skip
  s_cmp_eq_u32 s58, 1
  s_cbranch_scc1 L_ck6_data
  v_readlane_b32 s38, v96, s28
  s_nop 0
  s_cmp_ge_u32 s38, 8
  s_cbranch_scc1 L_ck6_cntok
  global_load_dword v96, v8, s[24:25] sc1
  s_branch L_ck6_skip
L_ck6_data:
  s_nop 4
  v_max3_u32 v100, v48, v49, v50
  v_max3_u32 v101, v51, v52, v53
  v_max3_u32 v100, v100, v54, v55
  v_max3_u32 v101, v101, v56, v57
  v_max3_u32 v100, v100, v58, v59
  v_max3_u32 v101, v101, v60, v61
  v_max3_u32 v100, v100, v62, v63
  v_max3_u32 v101, v101, v240, v241
  v_max3_u32 v100, v100, v242, v243
  v_max3_u32 v101, v101, v244, v245
  v_max3_u32 v100, v100, v246, v247
  v_max3_u32 v101, v101, v248, v249
  v_max3_u32 v100, v100, v250, v251
  v_max3_u32 v101, v101, v252, v253
  v_max3_u32 v100, v100, v254, v255
  v_max_u32 v100, v100, v101
  v_cmp_eq_u32 vcc, -1, v100
  s_nop 0
  s_cbranch_vccnz L_ck6_cntok
  s_mov_b32 s58, 3
  s_branch L_ck6_skip
L_ck6_cntok:
  s_nop 4
  s_mov_b32 s58, 1
  global_load_dwordx4 v[48:51], v92, s[48:49] offset:1536 sc1
  global_load_dwordx4 v[52:55], v93, s[48:49] offset:1536 sc1
  global_load_dwordx4 v[56:59], v94, s[48:49] offset:1536 sc1
  global_load_dwordx4 v[60:63], v95, s[48:49] offset:1536 sc1
  global_load_dwordx4 v[240:243], v92, s[48:49] offset:1024 sc1
  global_load_dwordx4 v[244:247], v93, s[48:49] offset:1024 sc1
  global_load_dwordx4 v[248:251], v94, s[48:49] offset:1024 sc1
  global_load_dwordx4 v[252:255], v95, s[48:49] offset:1024 sc1
L_ck6_skip:
  s_nop 4
  s_branch L_pqloop
L_flagspin:
  s_nop 4
  s_mov_b32 s47, 0
L_flagloop:
  s_nop 4
  ds_read_b32 v102, v97 offset:8256
  s_add_u32 s47, s47, 1
  s_cmp_ge_u32 s47, 12800000
  s_cbranch_scc1 L_b2
  s_waitcnt lgkmcnt(0)
  v_readfirstlane_b32 s38, v102
  s_nop 0
  s_cmp_eq_u32 s38, 1
  s_cbranch_scc0 L_flagloop
  s_branch L_b2
L_pqok:
  s_nop 4
  v_add_f32 v48, v48, v52
  v_add_f32 v56, v56, v60
  v_add_f32 v240, v240, v244
  v_add_f32 v248, v248, v252
  v_add_f32 v49, v49, v53
  v_add_f32 v57, v57, v61
  v_add_f32 v241, v241, v245
  v_add_f32 v249, v249, v253
  v_add_f32 v50, v50, v54
  v_add_f32 v58, v58, v62
  v_add_f32 v242, v242, v246
  v_add_f32 v250, v250, v254
  v_add_f32 v51, v51, v55
  v_add_f32 v59, v59, v63
  v_add_f32 v243, v243, v247
  v_add_f32 v251, v251, v255
  v_add_f32 v48, v48, v56
  v_add_f32 v240, v240, v248
  v_add_f32 v49, v49, v57
  v_add_f32 v241, v241, v249
  v_add_f32 v50, v50, v58
  v_add_f32 v242, v242, v250
  v_add_f32 v51, v51, v59
  v_add_f32 v243, v243, v251
  v_mov_b32 v52, v48
  s_nop 1
  v_permlane32_swap_b32 v48, v52
  v_add_f32 v48, v48, v52
  v_mov_b32 v244, v240
  s_nop 1
  v_permlane32_swap_b32 v240, v244
  v_add_f32 v240, v240, v244
  v_mov_b32 v53, v49
  s_nop 1
  v_permlane32_swap_b32 v49, v53
  v_add_f32 v49, v49, v53
  v_mov_b32 v245, v241
  s_nop 1
  v_permlane32_swap_b32 v241, v245
  v_add_f32 v241, v241, v245
  v_mov_b32 v54, v50
  s_nop 1
  v_permlane32_swap_b32 v50, v54
  v_add_f32 v50, v50, v54
  v_mov_b32 v246, v242
  s_nop 1
  v_permlane32_swap_b32 v242, v246
  v_add_f32 v242, v242, v246
  v_mov_b32 v55, v51
  s_nop 1
  v_permlane32_swap_b32 v51, v55
  v_add_f32 v51, v51, v55
  v_mov_b32 v247, v243
  s_nop 1
  v_permlane32_swap_b32 v243, v247
  v_add_f32 v243, v243, v247
  v_cvt_pk_bf16_f32 v52, v48, v49
  v_cvt_pk_bf16_f32 v53, v50, v51
  v_lshlrev_b32 v5, 1, v8
  ds_write_b64 v5, v[52:53] offset:7552
  v_cvt_pk_bf16_f32 v240, 0, v240
  v_cvt_pk_bf16_f32 v241, 0, v241
  v_cvt_pk_bf16_f32 v242, 0, v242
  v_cvt_pk_bf16_f32 v243, 0, v243
  v_mov_b32 v244, v240
  s_nop 1
  v_permlane16_swap_b32 v240, v244
  v_mov_b32 v245, v241
  s_nop 1
  v_permlane16_swap_b32 v241, v245
  v_mov_b32 v246, v242
  s_nop 1
  v_permlane16_swap_b32 v242, v246
  v_mov_b32 v247, v243
  s_nop 1
  v_permlane16_swap_b32 v243, v247
  v_mul_f32 v240, 0xbfb8aa3b, v240
  v_min_f32 v240, 0x42fc0000, v240
  v_exp_f32 v240, v240
  s_nop 0
  v_add_f32 v240, 1.0, v240
  v_rcp_f32 v248, v240
  s_nop 0
  v_fma_f32 v252, -v248, v240, 1.0
  v_fma_f32 v248, v252, v248, v248
  v_cvt_pk_bf16_f32 v248, 0, v248
  v_mul_f32 v248, v248, v244
  v_cndmask_b32 v248, 0, v248, s[50:51]
  v_mul_f32 v241, 0xbfb8aa3b, v241
  v_min_f32 v241, 0x42fc0000, v241
  v_exp_f32 v241, v241
  s_nop 0
  v_add_f32 v241, 1.0, v241
  v_rcp_f32 v249, v241
  s_nop 0
  v_fma_f32 v253, -v249, v241, 1.0
  v_fma_f32 v249, v253, v249, v249
  v_cvt_pk_bf16_f32 v249, 0, v249
  v_mul_f32 v249, v249, v245
  v_cndmask_b32 v249, 0, v249, s[50:51]
  v_mul_f32 v242, 0xbfb8aa3b, v242
  v_min_f32 v242, 0x42fc0000, v242
  v_exp_f32 v242, v242
  s_nop 0
  v_add_f32 v242, 1.0, v242
  v_rcp_f32 v250, v242
  s_nop 0
  v_fma_f32 v254, -v250, v242, 1.0
  v_fma_f32 v250, v254, v250, v250
  v_cvt_pk_bf16_f32 v250, 0, v250
  v_mul_f32 v250, v250, v246
  v_cndmask_b32 v250, 0, v250, s[50:51]
  v_mul_f32 v243, 0xbfb8aa3b, v243
  v_min_f32 v243, 0x42fc0000, v243
  v_exp_f32 v243, v243
  s_nop 0
  v_add_f32 v243, 1.0, v243
  v_rcp_f32 v251, v243
  s_nop 0
  v_fma_f32 v255, -v251, v243, 1.0
  v_fma_f32 v251, v255, v251, v251
  v_cvt_pk_bf16_f32 v251, 0, v251
  v_mul_f32 v251, v251, v247
  v_cndmask_b32 v251, 0, v251, s[50:51]
  v_cvt_pk_bf16_f32 v240, v248, v249
  v_cvt_pk_bf16_f32 v241, v250, v251
  v_lshlrev_b32 v5, 3, v3
  ds_write_b64 v5, v[240:241] offset:7808
  v_mov_b32 v102, 1
  s_waitcnt lgkmcnt(0)
  ds_write_b32 v97, v102 offset:8256
L_b2:
  s_nop 4
  v_lshlrev_b32 v6, 4, v3
  ds_read_b128 v[88:91], v6 offset:7552
  v_mov_b32 v32, 0
  v_mov_b32 v33, 0
  v_mov_b32 v34, 0
  v_mov_b32 v35, 0
  v_mov_b32 v36, 0
  v_mov_b32 v37, 0
  v_mov_b32 v38, 0
  v_mov_b32 v39, 0
  v_mov_b32 v40, 0
  v_mov_b32 v41, 0
  v_mov_b32 v42, 0
  v_mov_b32 v43, 0
  v_mov_b32 v44, 0
  v_mov_b32 v45, 0
  v_mov_b32 v46, 0
  v_mov_b32 v47, 0
  s_waitcnt lgkmcnt(0)
  v_dot2c_f32_bf16 v32, v112, v88
  v_dot2c_f32_bf16 v33, v116, v88
  v_dot2c_f32_bf16 v34, v120, v88
  v_dot2c_f32_bf16 v35, v124, v88
  v_dot2c_f32_bf16 v36, v128, v88
  v_dot2c_f32_bf16 v37, v132, v88
  v_dot2c_f32_bf16 v38, v136, v88
  v_dot2c_f32_bf16 v39, v140, v88
  v_dot2c_f32_bf16 v40, v144, v88
  v_dot2c_f32_bf16 v41, v148, v88
  v_dot2c_f32_bf16 v42, v152, v88
  v_dot2c_f32_bf16 v43, v156, v88
  v_dot2c_f32_bf16 v44, v160, v88
  v_dot2c_f32_bf16 v45, v164, v88
  v_dot2c_f32_bf16 v46, v168, v88
  v_dot2c_f32_bf16 v47, v172, v88
  v_dot2c_f32_bf16 v32, v113, v89
  v_dot2c_f32_bf16 v33, v117, v89
  v_dot2c_f32_bf16 v34, v121, v89
  v_dot2c_f32_bf16 v35, v125, v89
  v_dot2c_f32_bf16 v36, v129, v89
  v_dot2c_f32_bf16 v37, v133, v89
  v_dot2c_f32_bf16 v38, v137, v89
  v_dot2c_f32_bf16 v39, v141, v89
  v_dot2c_f32_bf16 v40, v145, v89
  v_dot2c_f32_bf16 v41, v149, v89
  v_dot2c_f32_bf16 v42, v153, v89
  v_dot2c_f32_bf16 v43, v157, v89
  v_dot2c_f32_bf16 v44, v161, v89
  v_dot2c_f32_bf16 v45, v165, v89
  v_dot2c_f32_bf16 v46, v169, v89
  v_dot2c_f32_bf16 v47, v173, v89
  v_dot2c_f32_bf16 v32, v114, v90
  v_dot2c_f32_bf16 v33, v118, v90
  v_dot2c_f32_bf16 v34, v122, v90
  v_dot2c_f32_bf16 v35, v126, v90
  v_dot2c_f32_bf16 v36, v130, v90
  v_dot2c_f32_bf16 v37, v134, v90
  v_dot2c_f32_bf16 v38, v138, v90
  v_dot2c_f32_bf16 v39, v142, v90
  v_dot2c_f32_bf16 v40, v146, v90
  v_dot2c_f32_bf16 v41, v150, v90
  v_dot2c_f32_bf16 v42, v154, v90
  v_dot2c_f32_bf16 v43, v158, v90
  v_dot2c_f32_bf16 v44, v162, v90
  v_dot2c_f32_bf16 v45, v166, v90
  v_dot2c_f32_bf16 v46, v170, v90
  v_dot2c_f32_bf16 v47, v174, v90
  v_dot2c_f32_bf16 v32, v115, v91
  v_dot2c_f32_bf16 v33, v119, v91
  v_dot2c_f32_bf16 v34, v123, v91
  v_dot2c_f32_bf16 v35, v127, v91
  v_dot2c_f32_bf16 v36, v131, v91
  v_dot2c_f32_bf16 v37, v135, v91
  v_dot2c_f32_bf16 v38, v139, v91
  v_dot2c_f32_bf16 v39, v143, v91
  v_dot2c_f32_bf16 v40, v147, v91
  v_dot2c_f32_bf16 v41, v151, v91
  v_dot2c_f32_bf16 v42, v155, v91
  v_dot2c_f32_bf16 v43, v159, v91
  v_dot2c_f32_bf16 v44, v163, v91
  v_dot2c_f32_bf16 v45, v167, v91
  v_dot2c_f32_bf16 v46, v171, v91
  v_dot2c_f32_bf16 v47, v175, v91
  v_add_f32_dpp v32, v32, v32 row_ror:8 row_mask:0xf bank_mask:0x3
  s_nop 1
  v_add_f32_dpp v32, v40, v40 row_ror:8 row_mask:0xf bank_mask:0xc
  v_add_f32_dpp v33, v33, v33 row_ror:8 row_mask:0xf bank_mask:0x3
  s_nop 1
  v_add_f32_dpp v33, v41, v41 row_ror:8 row_mask:0xf bank_mask:0xc
  v_add_f32_dpp v34, v34, v34 row_ror:8 row_mask:0xf bank_mask:0x3
  s_nop 1
  v_add_f32_dpp v34, v42, v42 row_ror:8 row_mask:0xf bank_mask:0xc
  v_add_f32_dpp v35, v35, v35 row_ror:8 row_mask:0xf bank_mask:0x3
  s_nop 1
  v_add_f32_dpp v35, v43, v43 row_ror:8 row_mask:0xf bank_mask:0xc
  v_add_f32_dpp v36, v36, v36 row_ror:8 row_mask:0xf bank_mask:0x3
  s_nop 1
  v_add_f32_dpp v36, v44, v44 row_ror:8 row_mask:0xf bank_mask:0xc
  v_add_f32_dpp v37, v37, v37 row_ror:8 row_mask:0xf bank_mask:0x3
  s_nop 1
  v_add_f32_dpp v37, v45, v45 row_ror:8 row_mask:0xf bank_mask:0xc
  v_add_f32_dpp v38, v38, v38 row_ror:8 row_mask:0xf bank_mask:0x3
  s_nop 1
  v_add_f32_dpp v38, v46, v46 row_ror:8 row_mask:0xf bank_mask:0xc
  v_add_f32_dpp v39, v39, v39 row_ror:8 row_mask:0xf bank_mask:0x3
  s_nop 1
  v_add_f32_dpp v39, v47, v47 row_ror:8 row_mask:0xf bank_mask:0xc
  v_add_f32_dpp v32, v32, v32 row_half_mirror row_mask:0xf bank_mask:0x5
  s_nop 1
  v_add_f32_dpp v32, v36, v36 row_half_mirror row_mask:0xf bank_mask:0xa
  v_add_f32_dpp v33, v33, v33 row_half_mirror row_mask:0xf bank_mask:0x5
  s_nop 1
  v_add_f32_dpp v33, v37, v37 row_half_mirror row_mask:0xf bank_mask:0xa
  v_add_f32_dpp v34, v34, v34 row_half_mirror row_mask:0xf bank_mask:0x5
  s_nop 1
  v_add_f32_dpp v34, v38, v38 row_half_mirror row_mask:0xf bank_mask:0xa
  v_add_f32_dpp v35, v35, v35 row_half_mirror row_mask:0xf bank_mask:0x5
  s_nop 1
  v_add_f32_dpp v35, v39, v39 row_half_mirror row_mask:0xf bank_mask:0xa
  v_cndmask_b32 v36, v32, v34, s[30:31]
  v_cndmask_b32 v37, v34, v32, s[30:31]
  v_cndmask_b32 v38, v33, v35, s[30:31]
  v_cndmask_b32 v39, v35, v33, s[30:31]
  v_add_f32_dpp v32, v37, v36 quad_perm:[2,3,0,1] row_mask:0xf bank_mask:0xf
  s_nop 0
  v_add_f32_dpp v33, v39, v38 quad_perm:[2,3,0,1] row_mask:0xf bank_mask:0xf
  v_cndmask_b32 v34, v32, v33, s[52:53]
  v_cndmask_b32 v35, v33, v32, s[52:53]
  s_nop 1
  v_add_f32_dpp v32, v35, v34 quad_perm:[1,0,3,2] row_mask:0xf bank_mask:0xf
  s_cmp_gt_u32 s59, 28
  s_cbranch_scc1 L_g28
  global_load_dwordx4 v[200:203], v1, s[8:9] nt
  s_add_u32 s8, s8, 65536
  s_addc_u32 s9, s9, 0
L_g28:
  s_nop 4
  s_cmp_gt_u32 s59, 29
  s_cbranch_scc1 L_g29
  global_load_dwordx4 v[204:207], v1, s[8:9] nt
  s_add_u32 s8, s8, 65536
  s_addc_u32 s9, s9, 0
L_g29:
  s_nop 4
  s_cmp_gt_u32 s59, 30
  s_cbranch_scc1 L_g30
  global_load_dwordx4 v[208:211], v1, s[8:9] nt
  s_add_u32 s8, s8, 65536
  s_addc_u32 s9, s9, 0
L_g30:
  s_nop 4
  s_cmp_gt_u32 s59, 31
  s_cbranch_scc1 L_g31
  global_load_dwordx4 v[212:215], v1, s[8:9] nt
  s_add_u32 s8, s8, 65536
  s_addc_u32 s9, s9, 0
L_g31:
  s_nop 4
  v_cvt_pk_bf16_f32 v32, 0, v32
  v_mul_f32 v32, 0x3db504f3, v32
  v_cvt_pk_bf16_f32 v32, 0, v32
  v_mov_b32 v38, v32
  s_nop 1
  v_max_f32_dpp v38, v38, v38 row_ror:8 row_mask:0xf bank_mask:0xf
  s_nop 1
  v_max_f32_dpp v38, v38, v38 row_ror:4 row_mask:0xf bank_mask:0xf
  s_nop 1
  v_max_f32_dpp v38, v38, v38 row_ror:2 row_mask:0xf bank_mask:0xf
  s_nop 1
  v_max_f32_dpp v38, v38, v38 row_ror:1 row_mask:0xf bank_mask:0xf
  v_mov_b32 v34, v38
  s_nop 1
  v_permlane32_swap_b32 v38, v34
  v_max_f32 v38, v38, v34
  v_mov_b32 v34, v38
  s_nop 1
  v_permlane16_swap_b32 v38, v34
  v_max_f32 v38, v38, v34
  v_sub_f32 v39, v32, v38
  v_mul_f32 v39, 0x3fb8aa3b, v39
  v_exp_f32 v39, v39
  s_nop 1
  v_add_f32_dpp v39, v39, v39 row_ror:8 row_mask:0xf bank_mask:0xf
  s_nop 1
  v_add_f32_dpp v39, v39, v39 row_ror:4 row_mask:0xf bank_mask:0xf
  s_nop 1
  v_add_f32_dpp v39, v39, v39 row_ror:2 row_mask:0xf bank_mask:0xf
  s_nop 1
  v_add_f32_dpp v39, v39, v39 row_ror:1 row_mask:0xf bank_mask:0xf
  v_mov_b32 v35, v39
  s_nop 1
  v_permlane32_swap_b32 v39, v35
  v_add_f32 v39, v39, v35
  v_mov_b32 v35, v39
  s_nop 1
  v_permlane16_swap_b32 v39, v35
  v_add_f32 v39, v39, v35
  s_lshl_b32 s38, s3, 3
  v_mov_b32 v6, s38
  ds_write_b64 v6, v[38:39] offset:8192
  s_waitcnt lgkmcnt(0)
  s_barrier
  v_and_b32 v7, 7, v0
  v_lshlrev_b32 v7, 3, v7
  ds_read_b64 v[36:37], v7 offset:8192
  v_lshlrev_b32 v7, 1, v2
  ds_read_b32 v18, v7 offset:7808
  s_waitcnt lgkmcnt(0)
  v_mov_b32 v33, v36
  s_nop 1
  v_max_f32_dpp v33, v33, v33 row_ror:4 row_mask:0xf bank_mask:0xf
  s_nop 1
  v_max_f32_dpp v33, v33, v33 row_ror:2 row_mask:0xf bank_mask:0xf
  s_nop 1
  v_max_f32_dpp v33, v33, v33 row_ror:1 row_mask:0xf bank_mask:0xf
  v_sub_f32 v36, v36, v33
  v_mul_f32 v36, 0x3fb8aa3b, v36
  v_exp_f32 v36, v36
  v_min_u32 v23, 0xfffffffe, v33
  v_sub_f32 v32, v32, v33
  v_mul_f32 v32, 0x3fb8aa3b, v32
  v_exp_f32 v32, v32
  v_mul_f32 v22, v37, v36
  v_cvt_pk_bf16_f32 v34, v32, 0
  v_cvt_pk_bf16_f32 v35, 0, v32
  v_add_f32_dpp v22, v22, v22 row_ror:4 row_mask:0xf bank_mask:0xf
  s_nop 1
  v_add_f32_dpp v22, v22, v22 row_ror:2 row_mask:0xf bank_mask:0xf
  s_nop 1
  v_add_f32_dpp v22, v22, v22 row_ror:1 row_mask:0xf bank_mask:0xf
  v_min_u32 v22, 0xfffffffe, v22
  s_lshl_b32 s38, s3, 9
  v_add_u32 v10, s38, v4
  v_and_b32 v5, 7, v0
  v_lshrrev_b32 v6, 3, v0
  v_lshlrev_b32 v6, 9, v6
  v_lshl_add_u32 v6, v5, 3, v6
  s_lshl_b32 s38, s3, 6
  v_add_u32 v11, s38, v6
  s_lshl_b32 s38, s3, 7
  v_lshl_add_u32 v12, v5, 4, s38
  v_lshrrev_b32 v6, 1, v3
  v_mul_u32_u24 v6, 151552, v6
  v_and_b32 v7, 1, v3
  v_lshl_add_u32 v7, v7, 2, v15
  v_lshl_add_u32 v9, v7, 4, v6
  v_add_u32 v9, s38, v9
  v_cmp_gt_u32 s[56:57], 8, v0
  v_lshrrev_b32 v6, 1, v15
  v_mul_u32_u24 v6, 320, v6
  v_lshl_add_u32 v6, v3, 5, v6
  v_and_b32 v7, 1, v15
  v_lshl_add_u32 v6, v7, 4, v6
  s_mul_i32 s39, s3, 640
  v_add_u32 v14, s39, v6
  v_and_b32 v6, 31, v0
  v_lshrrev_b32 v7, 5, v0
  v_mul_u32_u24 v7, 2560, v7
  v_lshl_add_u32 v7, v6, 2, v7
  v_add_u32 v16, s38, v7
  v_lshl_add_u32 v17, v6, 2, s38
  v_and_b32 v19, 0xffff, v18
  v_lshlrev_b32 v20, 16, v18
  v_lshrrev_b32 v21, 16, v18
  v_and_b32 v18, 0xffff0000, v18
  v_mov_b32 v24, 0
  v_mov_b32 v25, 0
  v_mov_b32 v26, 0
  v_mov_b32 v27, 0
  v_mov_b32 v28, 0
  v_mov_b32 v29, 0
  v_mov_b32 v30, 0
  v_mov_b32 v31, 0
  s_waitcnt vmcnt(9)
  v_dot2c_f32_bf16_dpp v24, v34, v176 row_newbcast:0 row_mask:0xf bank_mask:0xf
  v_dot2c_f32_bf16_dpp v25, v35, v176 row_newbcast:0 row_mask:0xf bank_mask:0xf
  v_dot2c_f32_bf16_dpp v26, v34, v177 row_newbcast:0 row_mask:0xf bank_mask:0xf
  v_dot2c_f32_bf16_dpp v27, v35, v177 row_newbcast:0 row_mask:0xf bank_mask:0xf
  v_dot2c_f32_bf16_dpp v28, v34, v178 row_newbcast:0 row_mask:0xf bank_mask:0xf
  v_dot2c_f32_bf16_dpp v29, v35, v178 row_newbcast:0 row_mask:0xf bank_mask:0xf
  v_dot2c_f32_bf16_dpp v30, v34, v179 row_newbcast:0 row_mask:0xf bank_mask:0xf
  v_dot2c_f32_bf16_dpp v31, v35, v179 row_newbcast:0 row_mask:0xf bank_mask:0xf
  s_waitcnt vmcnt(8)
  v_dot2c_f32_bf16_dpp v24, v34, v180 row_newbcast:1 row_mask:0xf bank_mask:0xf
  v_dot2c_f32_bf16_dpp v25, v35, v180 row_newbcast:1 row_mask:0xf bank_mask:0xf
  v_dot2c_f32_bf16_dpp v26, v34, v181 row_newbcast:1 row_mask:0xf bank_mask:0xf
  v_dot2c_f32_bf16_dpp v27, v35, v181 row_newbcast:1 row_mask:0xf bank_mask:0xf
  v_dot2c_f32_bf16_dpp v28, v34, v182 row_newbcast:1 row_mask:0xf bank_mask:0xf
  v_dot2c_f32_bf16_dpp v29, v35, v182 row_newbcast:1 row_mask:0xf bank_mask:0xf
  v_dot2c_f32_bf16_dpp v30, v34, v183 row_newbcast:1 row_mask:0xf bank_mask:0xf
  v_dot2c_f32_bf16_dpp v31, v35, v183 row_newbcast:1 row_mask:0xf bank_mask:0xf
  s_waitcnt vmcnt(7)
  v_dot2c_f32_bf16_dpp v24, v34, v184 row_newbcast:2 row_mask:0xf bank_mask:0xf
  v_dot2c_f32_bf16_dpp v25, v35, v184 row_newbcast:2 row_mask:0xf bank_mask:0xf
  v_dot2c_f32_bf16_dpp v26, v34, v185 row_newbcast:2 row_mask:0xf bank_mask:0xf
  v_dot2c_f32_bf16_dpp v27, v35, v185 row_newbcast:2 row_mask:0xf bank_mask:0xf
  v_dot2c_f32_bf16_dpp v28, v34, v186 row_newbcast:2 row_mask:0xf bank_mask:0xf
  v_dot2c_f32_bf16_dpp v29, v35, v186 row_newbcast:2 row_mask:0xf bank_mask:0xf
  v_dot2c_f32_bf16_dpp v30, v34, v187 row_newbcast:2 row_mask:0xf bank_mask:0xf
  v_dot2c_f32_bf16_dpp v31, v35, v187 row_newbcast:2 row_mask:0xf bank_mask:0xf
  s_waitcnt vmcnt(6)
  v_dot2c_f32_bf16_dpp v24, v34, v188 row_newbcast:3 row_mask:0xf bank_mask:0xf
  v_dot2c_f32_bf16_dpp v25, v35, v188 row_newbcast:3 row_mask:0xf bank_mask:0xf
  v_dot2c_f32_bf16_dpp v26, v34, v189 row_newbcast:3 row_mask:0xf bank_mask:0xf
  v_dot2c_f32_bf16_dpp v27, v35, v189 row_newbcast:3 row_mask:0xf bank_mask:0xf
  v_dot2c_f32_bf16_dpp v28, v34, v190 row_newbcast:3 row_mask:0xf bank_mask:0xf
  v_dot2c_f32_bf16_dpp v29, v35, v190 row_newbcast:3 row_mask:0xf bank_mask:0xf
  v_dot2c_f32_bf16_dpp v30, v34, v191 row_newbcast:3 row_mask:0xf bank_mask:0xf
  v_dot2c_f32_bf16_dpp v31, v35, v191 row_newbcast:3 row_mask:0xf bank_mask:0xf
  s_waitcnt vmcnt(5)
  s_cmp_gt_u32 s59, 32
  s_cbranch_scc1 L_g32
  global_load_dwordx4 v[216:219], v1, s[8:9] nt
  s_add_u32 s8, s8, 65536
  s_addc_u32 s9, s9, 0
L_g32:
  s_nop 4
  v_dot2c_f32_bf16_dpp v24, v34, v192 row_newbcast:4 row_mask:0xf bank_mask:0xf
  v_dot2c_f32_bf16_dpp v25, v35, v192 row_newbcast:4 row_mask:0xf bank_mask:0xf
  v_dot2c_f32_bf16_dpp v26, v34, v193 row_newbcast:4 row_mask:0xf bank_mask:0xf
  v_dot2c_f32_bf16_dpp v27, v35, v193 row_newbcast:4 row_mask:0xf bank_mask:0xf
  v_dot2c_f32_bf16_dpp v28, v34, v194 row_newbcast:4 row_mask:0xf bank_mask:0xf
  v_dot2c_f32_bf16_dpp v29, v35, v194 row_newbcast:4 row_mask:0xf bank_mask:0xf
  v_dot2c_f32_bf16_dpp v30, v34, v195 row_newbcast:4 row_mask:0xf bank_mask:0xf
  v_dot2c_f32_bf16_dpp v31, v35, v195 row_newbcast:4 row_mask:0xf bank_mask:0xf
  s_waitcnt vmcnt(5)
  s_cmp_gt_u32 s59, 33
  s_cbranch_scc1 L_g33
  global_load_dwordx4 v[220:223], v1, s[8:9] nt
  s_add_u32 s8, s8, 65536
  s_addc_u32 s9, s9, 0
L_g33:
  s_nop 4
  v_dot2c_f32_bf16_dpp v24, v34, v196 row_newbcast:5 row_mask:0xf bank_mask:0xf
  v_dot2c_f32_bf16_dpp v25, v35, v196 row_newbcast:5 row_mask:0xf bank_mask:0xf
  v_dot2c_f32_bf16_dpp v26, v34, v197 row_newbcast:5 row_mask:0xf bank_mask:0xf
  v_dot2c_f32_bf16_dpp v27, v35, v197 row_newbcast:5 row_mask:0xf bank_mask:0xf
  v_dot2c_f32_bf16_dpp v28, v34, v198 row_newbcast:5 row_mask:0xf bank_mask:0xf
  v_dot2c_f32_bf16_dpp v29, v35, v198 row_newbcast:5 row_mask:0xf bank_mask:0xf
  v_dot2c_f32_bf16_dpp v30, v34, v199 row_newbcast:5 row_mask:0xf bank_mask:0xf
  v_dot2c_f32_bf16_dpp v31, v35, v199 row_newbcast:5 row_mask:0xf bank_mask:0xf
  s_waitcnt vmcnt(5)
  s_cmp_gt_u32 s59, 34
  s_cbranch_scc1 L_g34
  global_load_dwordx4 v[224:227], v1, s[8:9] nt
  s_add_u32 s8, s8, 65536
  s_addc_u32 s9, s9, 0
L_g34:
  s_nop 4
  v_dot2c_f32_bf16_dpp v24, v34, v200 row_newbcast:6 row_mask:0xf bank_mask:0xf
  v_dot2c_f32_bf16_dpp v25, v35, v200 row_newbcast:6 row_mask:0xf bank_mask:0xf
  v_dot2c_f32_bf16_dpp v26, v34, v201 row_newbcast:6 row_mask:0xf bank_mask:0xf
  v_dot2c_f32_bf16_dpp v27, v35, v201 row_newbcast:6 row_mask:0xf bank_mask:0xf
  v_dot2c_f32_bf16_dpp v28, v34, v202 row_newbcast:6 row_mask:0xf bank_mask:0xf
  v_dot2c_f32_bf16_dpp v29, v35, v202 row_newbcast:6 row_mask:0xf bank_mask:0xf
  v_dot2c_f32_bf16_dpp v30, v34, v203 row_newbcast:6 row_mask:0xf bank_mask:0xf
  v_dot2c_f32_bf16_dpp v31, v35, v203 row_newbcast:6 row_mask:0xf bank_mask:0xf
  s_waitcnt vmcnt(5)
  s_cmp_gt_u32 s59, 35
  s_cbranch_scc1 L_g35
  global_load_dwordx4 v[228:231], v1, s[8:9] nt
  s_add_u32 s8, s8, 65536
  s_addc_u32 s9, s9, 0
L_g35:
  s_nop 4
  v_dot2c_f32_bf16_dpp v24, v34, v204 row_newbcast:7 row_mask:0xf bank_mask:0xf
  v_dot2c_f32_bf16_dpp v25, v35, v204 row_newbcast:7 row_mask:0xf bank_mask:0xf
  v_dot2c_f32_bf16_dpp v26, v34, v205 row_newbcast:7 row_mask:0xf bank_mask:0xf
  v_dot2c_f32_bf16_dpp v27, v35, v205 row_newbcast:7 row_mask:0xf bank_mask:0xf
  v_dot2c_f32_bf16_dpp v28, v34, v206 row_newbcast:7 row_mask:0xf bank_mask:0xf
  v_dot2c_f32_bf16_dpp v29, v35, v206 row_newbcast:7 row_mask:0xf bank_mask:0xf
  v_dot2c_f32_bf16_dpp v30, v34, v207 row_newbcast:7 row_mask:0xf bank_mask:0xf
  v_dot2c_f32_bf16_dpp v31, v35, v207 row_newbcast:7 row_mask:0xf bank_mask:0xf
  s_waitcnt vmcnt(5)
  global_load_dwordx4 v[232:235], v1, s[8:9] nt
  s_add_u32 s8, s8, 65536
  s_addc_u32 s9, s9, 0
  v_dot2c_f32_bf16_dpp v24, v34, v208 row_newbcast:8 row_mask:0xf bank_mask:0xf
  v_dot2c_f32_bf16_dpp v25, v35, v208 row_newbcast:8 row_mask:0xf bank_mask:0xf
  v_dot2c_f32_bf16_dpp v26, v34, v209 row_newbcast:8 row_mask:0xf bank_mask:0xf
  v_dot2c_f32_bf16_dpp v27, v35, v209 row_newbcast:8 row_mask:0xf bank_mask:0xf
  v_dot2c_f32_bf16_dpp v28, v34, v210 row_newbcast:8 row_mask:0xf bank_mask:0xf
  v_dot2c_f32_bf16_dpp v29, v35, v210 row_newbcast:8 row_mask:0xf bank_mask:0xf
  v_dot2c_f32_bf16_dpp v30, v34, v211 row_newbcast:8 row_mask:0xf bank_mask:0xf
  v_dot2c_f32_bf16_dpp v31, v35, v211 row_newbcast:8 row_mask:0xf bank_mask:0xf
  s_waitcnt vmcnt(5)
  global_load_dwordx4 v[236:239], v1, s[8:9] nt
  v_dot2c_f32_bf16_dpp v24, v34, v212 row_newbcast:9 row_mask:0xf bank_mask:0xf
  v_dot2c_f32_bf16_dpp v25, v35, v212 row_newbcast:9 row_mask:0xf bank_mask:0xf
  v_dot2c_f32_bf16_dpp v26, v34, v213 row_newbcast:9 row_mask:0xf bank_mask:0xf
  v_dot2c_f32_bf16_dpp v27, v35, v213 row_newbcast:9 row_mask:0xf bank_mask:0xf
  v_dot2c_f32_bf16_dpp v28, v34, v214 row_newbcast:9 row_mask:0xf bank_mask:0xf
  v_dot2c_f32_bf16_dpp v29, v35, v214 row_newbcast:9 row_mask:0xf bank_mask:0xf
  v_dot2c_f32_bf16_dpp v30, v34, v215 row_newbcast:9 row_mask:0xf bank_mask:0xf
  v_dot2c_f32_bf16_dpp v31, v35, v215 row_newbcast:9 row_mask:0xf bank_mask:0xf
  s_waitcnt vmcnt(5)
  s_mov_b64 s[32:33], exec
  s_mov_b64 exec, s[34:35]
  global_load_dwordx4 v[64:67], v98, s[12:13] offset:0 nt
  s_mov_b64 exec, s[32:33]
  v_dot2c_f32_bf16_dpp v24, v34, v216 row_newbcast:10 row_mask:0xf bank_mask:0xf
  v_dot2c_f32_bf16_dpp v25, v35, v216 row_newbcast:10 row_mask:0xf bank_mask:0xf
  v_dot2c_f32_bf16_dpp v26, v34, v217 row_newbcast:10 row_mask:0xf bank_mask:0xf
  v_dot2c_f32_bf16_dpp v27, v35, v217 row_newbcast:10 row_mask:0xf bank_mask:0xf
  v_dot2c_f32_bf16_dpp v28, v34, v218 row_newbcast:10 row_mask:0xf bank_mask:0xf
  v_dot2c_f32_bf16_dpp v29, v35, v218 row_newbcast:10 row_mask:0xf bank_mask:0xf
  v_dot2c_f32_bf16_dpp v30, v34, v219 row_newbcast:10 row_mask:0xf bank_mask:0xf
  v_dot2c_f32_bf16_dpp v31, v35, v219 row_newbcast:10 row_mask:0xf bank_mask:0xf
  s_waitcnt vmcnt(5)
  s_mov_b64 s[32:33], exec
  s_mov_b64 exec, s[34:35]
  global_load_dwordx4 v[68:71], v98, s[12:13] offset:1280 nt
  s_mov_b64 exec, s[32:33]
  v_dot2c_f32_bf16_dpp v24, v34, v220 row_newbcast:11 row_mask:0xf bank_mask:0xf
  v_dot2c_f32_bf16_dpp v25, v35, v220 row_newbcast:11 row_mask:0xf bank_mask:0xf
  v_dot2c_f32_bf16_dpp v26, v34, v221 row_newbcast:11 row_mask:0xf bank_mask:0xf
  v_dot2c_f32_bf16_dpp v27, v35, v221 row_newbcast:11 row_mask:0xf bank_mask:0xf
  v_dot2c_f32_bf16_dpp v28, v34, v222 row_newbcast:11 row_mask:0xf bank_mask:0xf
  v_dot2c_f32_bf16_dpp v29, v35, v222 row_newbcast:11 row_mask:0xf bank_mask:0xf
  v_dot2c_f32_bf16_dpp v30, v34, v223 row_newbcast:11 row_mask:0xf bank_mask:0xf
  v_dot2c_f32_bf16_dpp v31, v35, v223 row_newbcast:11 row_mask:0xf bank_mask:0xf
  s_waitcnt vmcnt(5)
  s_mov_b64 s[32:33], exec
  s_mov_b64 exec, s[34:35]
  global_load_dwordx4 v[72:75], v98, s[14:15] offset:0 nt
  s_mov_b64 exec, s[32:33]
  v_dot2c_f32_bf16_dpp v24, v34, v224 row_newbcast:12 row_mask:0xf bank_mask:0xf
  v_dot2c_f32_bf16_dpp v25, v35, v224 row_newbcast:12 row_mask:0xf bank_mask:0xf
  v_dot2c_f32_bf16_dpp v26, v34, v225 row_newbcast:12 row_mask:0xf bank_mask:0xf
  v_dot2c_f32_bf16_dpp v27, v35, v225 row_newbcast:12 row_mask:0xf bank_mask:0xf
  v_dot2c_f32_bf16_dpp v28, v34, v226 row_newbcast:12 row_mask:0xf bank_mask:0xf
  v_dot2c_f32_bf16_dpp v29, v35, v226 row_newbcast:12 row_mask:0xf bank_mask:0xf
  v_dot2c_f32_bf16_dpp v30, v34, v227 row_newbcast:12 row_mask:0xf bank_mask:0xf
  v_dot2c_f32_bf16_dpp v31, v35, v227 row_newbcast:12 row_mask:0xf bank_mask:0xf
  s_waitcnt vmcnt(5)
  s_mov_b64 s[32:33], exec
  s_mov_b64 exec, s[34:35]
  global_load_dwordx4 v[76:79], v98, s[14:15] offset:1280 nt
  s_mov_b64 exec, s[32:33]
  v_dot2c_f32_bf16_dpp v24, v34, v228 row_newbcast:13 row_mask:0xf bank_mask:0xf
  v_dot2c_f32_bf16_dpp v25, v35, v228 row_newbcast:13 row_mask:0xf bank_mask:0xf
  v_dot2c_f32_bf16_dpp v26, v34, v229 row_newbcast:13 row_mask:0xf bank_mask:0xf
  v_dot2c_f32_bf16_dpp v27, v35, v229 row_newbcast:13 row_mask:0xf bank_mask:0xf
  v_dot2c_f32_bf16_dpp v28, v34, v230 row_newbcast:13 row_mask:0xf bank_mask:0xf
  v_dot2c_f32_bf16_dpp v29, v35, v230 row_newbcast:13 row_mask:0xf bank_mask:0xf
  v_dot2c_f32_bf16_dpp v30, v34, v231 row_newbcast:13 row_mask:0xf bank_mask:0xf
  v_dot2c_f32_bf16_dpp v31, v35, v231 row_newbcast:13 row_mask:0xf bank_mask:0xf
  s_waitcnt vmcnt(5)
  s_mov_b64 s[32:33], exec
  s_mov_b64 exec, s[34:35]
  global_load_dwordx4 v[80:83], v99, s[20:21] offset:0 nt
  s_mov_b64 exec, s[32:33]
  v_dot2c_f32_bf16_dpp v24, v34, v232 row_newbcast:14 row_mask:0xf bank_mask:0xf
  v_dot2c_f32_bf16_dpp v25, v35, v232 row_newbcast:14 row_mask:0xf bank_mask:0xf
  v_dot2c_f32_bf16_dpp v26, v34, v233 row_newbcast:14 row_mask:0xf bank_mask:0xf
  v_dot2c_f32_bf16_dpp v27, v35, v233 row_newbcast:14 row_mask:0xf bank_mask:0xf
  v_dot2c_f32_bf16_dpp v28, v34, v234 row_newbcast:14 row_mask:0xf bank_mask:0xf
  v_dot2c_f32_bf16_dpp v29, v35, v234 row_newbcast:14 row_mask:0xf bank_mask:0xf
  v_dot2c_f32_bf16_dpp v30, v34, v235 row_newbcast:14 row_mask:0xf bank_mask:0xf
  v_dot2c_f32_bf16_dpp v31, v35, v235 row_newbcast:14 row_mask:0xf bank_mask:0xf
  s_waitcnt vmcnt(5)
  s_mov_b64 s[32:33], exec
  s_mov_b64 exec, s[34:35]
  global_load_dwordx4 v[84:87], v99, s[20:21] offset:1280 nt
  s_mov_b64 exec, s[32:33]
  v_dot2c_f32_bf16_dpp v24, v34, v236 row_newbcast:15 row_mask:0xf bank_mask:0xf
  v_dot2c_f32_bf16_dpp v25, v35, v236 row_newbcast:15 row_mask:0xf bank_mask:0xf
  v_dot2c_f32_bf16_dpp v26, v34, v237 row_newbcast:15 row_mask:0xf bank_mask:0xf
  v_dot2c_f32_bf16_dpp v27, v35, v237 row_newbcast:15 row_mask:0xf bank_mask:0xf
  v_dot2c_f32_bf16_dpp v28, v34, v238 row_newbcast:15 row_mask:0xf bank_mask:0xf
  v_dot2c_f32_bf16_dpp v29, v35, v238 row_newbcast:15 row_mask:0xf bank_mask:0xf
  v_dot2c_f32_bf16_dpp v30, v34, v239 row_newbcast:15 row_mask:0xf bank_mask:0xf
  v_dot2c_f32_bf16_dpp v31, v35, v239 row_newbcast:15 row_mask:0xf bank_mask:0xf
  v_permlane32_swap_b32 v24, v28
  v_permlane32_swap_b32 v25, v29
  v_permlane32_swap_b32 v26, v30
  v_permlane32_swap_b32 v27, v31
  v_add_f32 v24, v24, v28
  v_add_f32 v25, v25, v29
  v_add_f32 v26, v26, v30
  v_add_f32 v27, v27, v31
  s_nop 0
  v_permlane16_swap_b32 v24, v26
  v_permlane16_swap_b32 v25, v27
  v_add_f32 v24, v24, v26
  v_add_f32 v25, v25, v27
  ds_write_b64 v10, v[24:25] offset:8320
  v_mov_b32 v50, v23
  v_mov_b32 v51, v22
  s_waitcnt lgkmcnt(0)
  s_barrier
  ds_read_b64 v[48:49], v11 offset:8320
  s_waitcnt lgkmcnt(0)
  v_add_f32_dpp v48, v48, v48 row_ror:8 row_mask:0xf bank_mask:0xf
  v_add_f32_dpp v49, v49, v49 row_ror:8 row_mask:0xf bank_mask:0xf
  v_mov_b32 v52, v48
  v_mov_b32 v53, v49
  s_nop 0
  v_permlane32_swap_b32 v48, v52
  v_permlane32_swap_b32 v49, v53
  v_add_f32 v48, v48, v52
  v_add_f32 v49, v49, v53
  v_mov_b32 v52, v48
  v_mov_b32 v53, v49
  s_nop 0
  v_permlane16_swap_b32 v48, v52
  v_permlane16_swap_b32 v49, v53
  v_add_f32 v48, v48, v52
  v_add_f32 v49, v49, v53
  v_min_u32 v48, 0xfffffffe, v48
  v_min_u32 v49, 0xfffffffe, v49
  s_mov_b64 s[32:33], exec
  s_mov_b64 exec, s[56:57]
  global_store_dwordx4 v12, v[48:51], s[44:45] offset:2688
  global_store_dwordx4 v12, v[48:51], s[44:45] offset:0 sc1
  s_mov_b64 exec, s[32:33]
  global_load_dwordx4 v[100:103], v9, s[48:49] offset:2688 sc1
  s_cmp_lg_u32 s28, s29
  s_cbranch_scc1 L_nofc
  s_cmp_lg_u32 s3, 7
  s_cbranch_scc1 L_nofc
  s_mov_b32 s47, 0
L_poll_c:
  s_nop 4
  global_load_dword v48, v8, s[24:25] sc1
  s_waitcnt vmcnt(0)
  v_cmp_gt_u32 vcc, 8, v48
  s_nop 0
  s_cbranch_vccz L_nofc
  s_add_u32 s47, s47, 1
  s_cmp_lt_u32 s47, 200000
  s_cbranch_scc1 L_poll_c
L_nofc:
  s_nop 4
  v_mov_b32 v24, 0
  v_mov_b32 v25, 0
  v_mov_b32 v26, 0
  v_mov_b32 v27, 0
  v_mov_b32 v28, 0
  v_mov_b32 v29, 0
  v_mov_b32 v30, 0
  v_mov_b32 v31, 0
  v_mov_b32 v32, 0
  v_mov_b32 v33, 0
  v_mov_b32 v34, 0
  v_mov_b32 v35, 0
  v_mov_b32 v36, 0
  v_mov_b32 v37, 0
  v_mov_b32 v38, 0
  v_mov_b32 v39, 0
  s_waitcnt vmcnt(3)
  v_cndmask_b32 v80, 0, v80, s[50:51]
  v_cndmask_b32 v81, 0, v81, s[50:51]
  v_cndmask_b32 v82, 0, v82, s[50:51]
  v_cndmask_b32 v83, 0, v83, s[50:51]
  v_cndmask_b32 v84, 0, v84, s[50:51]
  v_cndmask_b32 v85, 0, v85, s[50:51]
  v_cndmask_b32 v86, 0, v86, s[50:51]
  v_cndmask_b32 v87, 0, v87, s[50:51]
  v_dot2c_f32_bf16 v32, v19, v80
  v_dot2c_f32_bf16 v33, v20, v80
  v_dot2c_f32_bf16 v34, v19, v81
  v_dot2c_f32_bf16 v35, v20, v81
  v_dot2c_f32_bf16 v36, v19, v82
  v_dot2c_f32_bf16 v37, v20, v82
  v_dot2c_f32_bf16 v38, v19, v83
  v_dot2c_f32_bf16 v39, v20, v83
  v_dot2c_f32_bf16 v32, v21, v84
  v_dot2c_f32_bf16 v33, v18, v84
  v_dot2c_f32_bf16 v34, v21, v85
  v_dot2c_f32_bf16 v35, v18, v85
  v_dot2c_f32_bf16 v36, v21, v86
  v_dot2c_f32_bf16 v37, v18, v86
  v_dot2c_f32_bf16 v38, v21, v87
  v_dot2c_f32_bf16 v39, v18, v87
  s_mov_b32 s47, 0
L_poll_o:
  s_nop 4
  s_waitcnt vmcnt(0)
  v_max3_u32 v52, v100, v101, v102
  v_max_u32 v52, v52, v103
  v_cmp_eq_u32 vcc, -1, v52
  s_nop 0
  s_cbranch_vccz L_poll_o_ok0
  global_load_dwordx4 v[100:103], v9, s[48:49] offset:2688 sc1
  s_waitcnt vmcnt(0)
  v_max3_u32 v52, v100, v101, v102
  v_max_u32 v52, v52, v103
  v_cmp_eq_u32 vcc, -1, v52
  s_nop 0
  s_cbranch_vccz L_poll_o_ok0
  global_load_dwordx4 v[100:103], v9, s[48:49] offset:2688 sc1
  s_waitcnt vmcnt(0)
  v_max3_u32 v52, v100, v101, v102
  v_max_u32 v52, v52, v103
  v_cmp_eq_u32 vcc, -1, v52
  s_nop 0
  s_cbranch_vccz L_poll_o_ok0
  global_load_dwordx4 v[100:103], v9, s[48:49] offset:2688 sc1
  s_waitcnt vmcnt(0)
  v_max3_u32 v52, v100, v101, v102
  v_max_u32 v52, v52, v103
  v_cmp_eq_u32 vcc, -1, v52
  s_nop 0
  s_cbranch_vccz L_poll_o_ok0
  global_load_dwordx4 v[100:103], v9, s[48:49] offset:0 sc1
  s_add_u32 s47, s47, 1
  s_cmp_lt_u32 s47, 200000
  s_cbranch_scc1 L_poll_o
L_poll_o_ok0:
  s_nop 4
  v_mov_b32 v48, v100
  v_mov_b32 v49, v101
  v_mov_b32 v50, v102
  v_mov_b32 v51, v103
L_poll_o_ok:
  s_nop 4
  v_mov_b32 v52, v50
  s_nop 1
  v_max_f32_dpp v52, v52, v52 row_ror:8 row_mask:0xf bank_mask:0xf
  s_nop 1
  v_max_f32_dpp v52, v52, v52 row_ror:4 row_mask:0xf bank_mask:0xf
  s_nop 1
  v_max_f32_dpp v52, v52, v52 row_ror:2 row_mask:0xf bank_mask:0xf
  v_sub_f32 v50, v50, v52
  v_mul_f32 v50, 0x3fb8aa3b, v50
  v_exp_f32 v50, v50
  s_nop 0
  v_mul_f32 v51, v51, v50
  v_mul_f32 v48, v48, v50
  v_mul_f32 v49, v49, v50
  v_add_f32_dpp v51, v51, v51 row_ror:8 row_mask:0xf bank_mask:0xf
  v_add_f32_dpp v48, v48, v48 row_ror:8 row_mask:0xf bank_mask:0xf
  v_add_f32_dpp v49, v49, v49 row_ror:8 row_mask:0xf bank_mask:0xf
  v_add_f32_dpp v51, v51, v51 row_ror:4 row_mask:0xf bank_mask:0xf
  v_add_f32_dpp v48, v48, v48 row_ror:4 row_mask:0xf bank_mask:0xf
  v_add_f32_dpp v49, v49, v49 row_ror:4 row_mask:0xf bank_mask:0xf
  v_add_f32_dpp v51, v51, v51 row_ror:2 row_mask:0xf bank_mask:0xf
  v_add_f32_dpp v48, v48, v48 row_ror:2 row_mask:0xf bank_mask:0xf
  v_add_f32_dpp v49, v49, v49 row_ror:2 row_mask:0xf bank_mask:0xf
  v_rcp_f32 v52, v51
  s_nop 0
  v_mul_f32 v53, v48, v52
  v_mul_f32 v54, v49, v52
  v_fma_f32 v55, -v53, v51, v48
  v_fma_f32 v56, -v54, v51, v49
  v_fma_f32 v53, v55, v52, v53
  v_fma_f32 v54, v56, v52, v54
  v_cvt_pk_bf16_f32 v55, v53, 0
  v_cvt_pk_bf16_f32 v56, 0, v53
  v_cvt_pk_bf16_f32 v57, v54, 0
  v_cvt_pk_bf16_f32 v58, 0, v54
  v_dot2c_f32_bf16_dpp v24, v55, v64 row_newbcast:0 row_mask:0xf bank_mask:0xf
  v_dot2c_f32_bf16_dpp v25, v56, v64 row_newbcast:0 row_mask:0xf bank_mask:0xf
  v_dot2c_f32_bf16_dpp v26, v55, v65 row_newbcast:0 row_mask:0xf bank_mask:0xf
  v_dot2c_f32_bf16_dpp v27, v56, v65 row_newbcast:0 row_mask:0xf bank_mask:0xf
  v_dot2c_f32_bf16_dpp v28, v55, v66 row_newbcast:0 row_mask:0xf bank_mask:0xf
  v_dot2c_f32_bf16_dpp v29, v56, v66 row_newbcast:0 row_mask:0xf bank_mask:0xf
  v_dot2c_f32_bf16_dpp v30, v55, v67 row_newbcast:0 row_mask:0xf bank_mask:0xf
  v_dot2c_f32_bf16_dpp v31, v56, v67 row_newbcast:0 row_mask:0xf bank_mask:0xf
  v_dot2c_f32_bf16_dpp v24, v57, v68 row_newbcast:0 row_mask:0xf bank_mask:0xf
  v_dot2c_f32_bf16_dpp v25, v58, v68 row_newbcast:0 row_mask:0xf bank_mask:0xf
  v_dot2c_f32_bf16_dpp v26, v57, v69 row_newbcast:0 row_mask:0xf bank_mask:0xf
  v_dot2c_f32_bf16_dpp v27, v58, v69 row_newbcast:0 row_mask:0xf bank_mask:0xf
  v_dot2c_f32_bf16_dpp v28, v57, v70 row_newbcast:0 row_mask:0xf bank_mask:0xf
  v_dot2c_f32_bf16_dpp v29, v58, v70 row_newbcast:0 row_mask:0xf bank_mask:0xf
  v_dot2c_f32_bf16_dpp v30, v57, v71 row_newbcast:0 row_mask:0xf bank_mask:0xf
  v_dot2c_f32_bf16_dpp v31, v58, v71 row_newbcast:0 row_mask:0xf bank_mask:0xf
  v_dot2c_f32_bf16_dpp v24, v55, v72 row_newbcast:1 row_mask:0xf bank_mask:0xf
  v_dot2c_f32_bf16_dpp v25, v56, v72 row_newbcast:1 row_mask:0xf bank_mask:0xf
  v_dot2c_f32_bf16_dpp v26, v55, v73 row_newbcast:1 row_mask:0xf bank_mask:0xf
  v_dot2c_f32_bf16_dpp v27, v56, v73 row_newbcast:1 row_mask:0xf bank_mask:0xf
  v_dot2c_f32_bf16_dpp v28, v55, v74 row_newbcast:1 row_mask:0xf bank_mask:0xf
  v_dot2c_f32_bf16_dpp v29, v56, v74 row_newbcast:1 row_mask:0xf bank_mask:0xf
  v_dot2c_f32_bf16_dpp v30, v55, v75 row_newbcast:1 row_mask:0xf bank_mask:0xf
  v_dot2c_f32_bf16_dpp v31, v56, v75 row_newbcast:1 row_mask:0xf bank_mask:0xf
  v_dot2c_f32_bf16_dpp v24, v57, v76 row_newbcast:1 row_mask:0xf bank_mask:0xf
  v_dot2c_f32_bf16_dpp v25, v58, v76 row_newbcast:1 row_mask:0xf bank_mask:0xf
  v_dot2c_f32_bf16_dpp v26, v57, v77 row_newbcast:1 row_mask:0xf bank_mask:0xf
  v_dot2c_f32_bf16_dpp v27, v58, v77 row_newbcast:1 row_mask:0xf bank_mask:0xf
  v_dot2c_f32_bf16_dpp v28, v57, v78 row_newbcast:1 row_mask:0xf bank_mask:0xf
  v_dot2c_f32_bf16_dpp v29, v58, v78 row_newbcast:1 row_mask:0xf bank_mask:0xf
  v_dot2c_f32_bf16_dpp v30, v57, v79 row_newbcast:1 row_mask:0xf bank_mask:0xf
  v_dot2c_f32_bf16_dpp v31, v58, v79 row_newbcast:1 row_mask:0xf bank_mask:0xf
  v_permlane32_swap_b32 v24, v32
  v_permlane32_swap_b32 v25, v33
  v_permlane32_swap_b32 v26, v34
  v_permlane32_swap_b32 v27, v35
  v_permlane32_swap_b32 v28, v36
  v_permlane32_swap_b32 v29, v37
  v_permlane32_swap_b32 v30, v38
  v_permlane32_swap_b32 v31, v39
  v_add_f32 v24, v24, v32
  v_add_f32 v25, v25, v33
  v_add_f32 v26, v26, v34
  v_add_f32 v27, v27, v35
  v_add_f32 v28, v28, v36
  v_add_f32 v29, v29, v37
  v_add_f32 v30, v30, v38
  v_add_f32 v31, v31, v39
  v_permlane16_swap_b32 v24, v28
  v_permlane16_swap_b32 v25, v29
  v_permlane16_swap_b32 v26, v30
  v_permlane16_swap_b32 v27, v31
  v_add_f32 v24, v24, v28
  v_add_f32 v25, v25, v29
  v_add_f32 v26, v26, v30
  v_add_f32 v27, v27, v31
  s_mov_b64 s[32:33], exec
  s_mov_b64 exec, s[34:35]
  ds_write_b128 v14, v[24:27] offset:12416
  s_mov_b64 exec, s[32:33]
  s_waitcnt lgkmcnt(0)
  s_barrier
  s_cmp_gt_u32 s3, 4
  s_cbranch_scc1 L_pub2done
  ds_read_b32 v48, v16 offset:12416
  ds_read_b32 v49, v16 offset:13056
  ds_read_b32 v50, v16 offset:13696
  ds_read_b32 v51, v16 offset:14336
  s_waitcnt lgkmcnt(0)
  v_add_f32 v48, v48, v49
  v_add_f32 v50, v50, v51
  v_add_f32 v48, v48, v50
  v_mov_b32 v49, v48
  s_nop 1
  v_permlane32_swap_b32 v48, v49
  v_add_f32 v48, v48, v49
  v_min_u32 v48, 0xfffffffe, v48
  s_mov_b64 s[32:33], exec
  s_mov_b64 exec, s[54:55]
  global_store_dword v17, v48, s[44:45] offset:2048 sc1
  s_mov_b64 exec, s[32:33]
L_pub2done:
  s_nop 4
  s_cmp_lg_u32 s28, s29
  s_cbranch_scc1 L_fin_end
  s_mul_i32 s38, s29, 151552
  s_mul_i32 s39, s3, 18944
  s_add_u32 s38, s38, s39
  s_add_u32 s38, s38, 2048
  s_add_u32 s40, s26, s38
  s_addc_u32 s41, s27, 0
  s_add_u32 s42, s40, 9472
  s_addc_u32 s43, s41, 0
  v_lshlrev_b32 v6, 4, v0
  v_add_u32 v10, 4736, v6
  s_mul_i32 s38, s29, 160
  s_lshl_b32 s39, s3, 5
  s_add_u32 s38, s38, s39
  v_lshl_add_u32 v8, v3, 1, s38
  v_min_u32 v8, 1278, v8
  global_load_ushort v9, v8, s[4:5]
  v_cmp_gt_u32 vcc, 40, v0
  s_nop 0
  s_and_saveexec_b64 s[32:33], vcc
  s_mov_b32 s47, 0
L_poll_y:
  s_nop 4
  global_load_dwordx4 v[24:27], v6, s[40:41] sc1
  global_load_dwordx4 v[28:31], v10, s[40:41] sc1
  global_load_dwordx4 v[32:35], v6, s[42:43] sc1
  global_load_dwordx4 v[36:39], v10, s[42:43] sc1
  s_waitcnt vmcnt(0)
  v_max3_u32 v48, v24, v25, v26
  v_max3_u32 v49, v27, v28, v29
  v_max3_u32 v50, v30, v31, v32
  v_max3_u32 v51, v33, v34, v35
  v_max3_u32 v52, v36, v37, v38
  v_max3_u32 v48, v48, v49, v39
  v_max3_u32 v50, v50, v51, v52
  v_max_u32 v48, v48, v50
  v_cmp_eq_u32 vcc, -1, v48
  s_nop 0
  s_cbranch_vccz L_poll_y_ok
  s_add_u32 s47, s47, 1
  s_cmp_lt_u32 s47, 200000
  s_cbranch_scc1 L_poll_y
L_poll_y_ok:
  s_nop 4
  v_add_f32 v24, v24, v28
  v_add_f32 v32, v32, v36
  v_add_f32 v25, v25, v29
  v_add_f32 v33, v33, v37
  v_add_f32 v26, v26, v30
  v_add_f32 v34, v34, v38
  v_add_f32 v27, v27, v31
  v_add_f32 v35, v35, v39
  v_add_f32 v24, v24, v32
  v_add_f32 v25, v25, v33
  v_add_f32 v26, v26, v34
  v_add_f32 v27, v27, v35
  s_mul_i32 s38, s3, 640
  v_add_u32 v7, s38, v6
  ds_write_b128 v7, v[24:27] offset:17536
  s_mov_b64 exec, s[32:33]
  s_waitcnt lgkmcnt(0)
  s_barrier
  s_cmp_gt_u32 s3, 4
  s_cbranch_scc1 L_fin_end
  v_lshrrev_b32 v6, 1, v15
  v_mul_u32_u24 v6, 320, v6
  v_and_b32 v7, 1, v15
  v_mul_u32_u24 v7, 2560, v7
  v_add_u32 v6, v6, v7
  v_lshl_add_u32 v6, v3, 2, v6
  s_lshl_b32 s38, s3, 6
  v_add_u32 v6, s38, v6
  ds_read_b32 v48, v6 offset:17536
  ds_read_b32 v49, v6 offset:18176
  ds_read_b32 v50, v6 offset:18816
  ds_read_b32 v51, v6 offset:19456
  s_waitcnt lgkmcnt(0)
  v_add_f32 v48, v48, v49
  v_add_f32 v50, v50, v51
  v_add_f32 v48, v48, v50
  v_mov_b32 v49, v48
  s_nop 1
  v_permlane16_swap_b32 v48, v49
  v_add_f32 v48, v48, v49
  v_cvt_pk_bf16_f32 v48, 0, v48
  v_mov_b32 v49, v48
  s_nop 1
  v_permlane32_swap_b32 v48, v49
  v_lshlrev_b32 v9, 16, v9
  v_add_f32 v48, v9, v48
  v_cvt_pk_bf16_f32 v48, 0, v48
  v_add_f32 v48, v48, v49
  v_cvt_pk_bf16_f32 v48, v48, 0
  v_cmp_gt_u32 vcc, 16, v0
  s_nop 0
  s_and_saveexec_b64 s[32:33], vcc
  global_store_short v8, v48, s[22:23]
  s_mov_b64 exec, s[32:33]
L_fin_end:
  s_nop 4
L_end:
  s_nop 4
  s_endpgm
.section .rodata,"a"
.p2align 6
.amdhsa_kernel parallel_sum__sliding_block_cached__glu_gated_glu__decode_kernel
  .amdhsa_next_free_vgpr 256
  .amdhsa_next_free_sgpr 102
  .amdhsa_accum_offset 256
  .amdhsa_group_segment_fixed_size 0
  .amdhsa_kernarg_size 96
  .amdhsa_user_sgpr_count 2
  .amdhsa_user_sgpr_kernarg_segment_ptr 1
  .amdhsa_system_sgpr_workgroup_id_x 1
.end_amdhsa_kernel
```
